```python
import torch

def _softmax(x, axis=-1):
    return torch.softmax(x, dim=axis)
def _gelu(x):
    return torch.nn.functional.gelu(x, approximate="tanh")
def _silu(x):
    return torch.nn.functional.silu(x)
def _sigmoid(x):
    return torch.sigmoid(x)
def _layernorm(x, axis=-1, eps=1e-5):
    m = x.mean(dim=axis, keepdim=True)
    v = x.var(dim=axis, keepdim=True, unbiased=False)
    return (x - m) / torch.sqrt(v + eps)
def _scatter_add(tgt, idx, src, axis=0):
    return tgt.clone().index_add_(axis, idx, src)
def _segment_sum(src, seg, n):
    out = torch.zeros((n,) + src.shape[1:], dtype=src.dtype)
    return out.index_add_(0, seg, src)
def _pad(x, pw):
    flat = tuple(v for pair in reversed(pw) for v in pair)
    return torch.nn.functional.pad(x, flat)

kernel_name = 'concat_heads__linear_attn_block__sliding_block__prompt'

def setup_inputs():

    _w = (lambda a: (lambda t: t.to(torch.bfloat16) if t.is_floating_point() else t)(torch.as_tensor(a)))
    def _A_setup():
        B, S, D = 1, 2048, 512
        return {
            "x": _w((lambda *s: torch.randn(*s, dtype=torch.bfloat16) * 0.05)(B, S, D)),
            "wqkv": _w((lambda *s: torch.randn(*s, dtype=torch.bfloat16) * 0.8)(D, 3 * D)),
            "wo": _w((lambda *s: torch.randn(*s, dtype=torch.bfloat16) * 0.8)(D, D)),
        }
    _A_in = _A_setup()

    def _B_setup():
        B, S, D = 1, 2048, 512
        return {
            "x": _w((lambda *s: torch.randn(*s, dtype=torch.bfloat16) * 0.2)(B, S, D)),
            "wqkv": _w((lambda *s: torch.randn(*s, dtype=torch.bfloat16) * 0.2)(D, 3 * D)),
            "wo": _w((lambda *s: torch.randn(*s, dtype=torch.bfloat16) * 0.05)(D, D)),
        }
    _B_in = _B_setup()

    return {
        "A_x": _A_in["x"],
        "A_wqkv": _A_in["wqkv"],
        "A_wo": _A_in["wo"],
        "B_x": _B_in["x"],
        "B_wqkv": _B_in["wqkv"],
        "B_wo": _B_in["wo"],
    }

def reference(A_x, A_wqkv, A_wo, B_x, B_wqkv, B_wo):
    def _A_ref(x, wqkv, wo):
        B, S, D = x.shape
        H = 32; Dh = D // H
        qkv = (lambda x, *d: x.permute(*d))((x @ wqkv).reshape(B, S, 3, H, Dh), 2, 0, 3, 1, 4)
        q, k, v = qkv[0], qkv[1], qkv[2]
        phi = lambda t: torch.where(t > 0, t + 1, torch.exp(t)) + 1e-6
        pq, pk = phi(q), phi(k)
        kv = torch.einsum("bhsd,bhse->bhde", pk, v)
        z = torch.einsum("bhsd->bhd", pk)
        num = torch.einsum("bhqd,bhde->bhqe", pq, kv)
        den = torch.einsum("bhqd,bhd->bhq", pq, z)[..., None] + 1e-6
        o = num / den
        return (lambda x, *d: x.permute(*d))(o, 0, 2, 1, 3).reshape(B, S, D) @ wo

    def _B_ref(x, wqkv, wo):
        B, S, D = x.shape
        H = 32; Dh = D // H; W = 256
        qkv = (lambda x, *d: x.permute(*d))((x @ wqkv).reshape(B, S, 3, H, Dh), 2, 0, 3, 1, 4)
        q, k, v = qkv[0], qkv[1], qkv[2]
        scores = torch.einsum("bhqd,bhkd->bhqk", q, k) * (Dh ** -0.5)
        idx = torch.arange(S)
        mask = (idx[:, None] - idx[None, :] >= 0) & (idx[:, None] - idx[None, :] < W)
        scores = torch.where(mask[None, None], scores, -1e9)
        p = _softmax(scores, axis=-1)
        o = torch.einsum("bhqk,bhkd->bhqd", p, v)
        return (lambda x, *d: x.permute(*d))(o, 0, 2, 1, 3).reshape(B, S, D) @ wo

    a = _A_ref(A_x, A_wqkv, A_wo)
    b = _B_ref(B_x, B_wqkv, B_wo)
    return torch.concatenate([a, b], axis=-1)
```

```asm
; @launch grid=(256,1,1) block=(512,1,1) lds=163840
.amdgcn_target "amdgcn-amd-amdhsa--gfx950"
.text
.globl concat_heads__linear_attn_block__sliding_block__prompt_kernel
.p2align 8
.type concat_heads__linear_attn_block__sliding_block__prompt_kernel,@function
concat_heads__linear_attn_block__sliding_block__prompt_kernel:
    s_cmp_ge_u32 s2, 256
    s_cbranch_scc1 concat_heads__linear_attn_block__sliding_block__prompt_kernel_end
    s_load_dwordx4 s[28:31], s[0:1], 0
    s_load_dwordx4 s[32:35], s[0:1], 24
    s_load_dwordx2 s[64:65], s[0:1], 16
    s_load_dwordx2 s[66:67], s[0:1], 40
    s_load_dwordx4 s[68:71], s[0:1], 48
    s_load_dwordx2 s[72:73], s[0:1], 64
    s_cmp_ge_u32 s2, 8
    s_cbranch_scc1 cpt_1
    v_lshrrev_b32 v2, 6, v0
    v_and_b32 v1, 63, v0
    v_subrev_u32 v2, 1, v2
    v_cmp_gt_u32 vcc, 3, v2
    s_getpc_b64 s[4:5]
cpt_1_pc:
    s_sub_u32 s4, s4, cpt_1_pc-concat_heads__linear_attn_block__sliding_block__prompt_kernel
    s_subb_u32 s5, s5, 0
    v_lshlrev_b32 v12, 13, v2
    v_lshl_add_u32 v12, v1, 7, v12
    v_min_u32 v12, concat_heads__linear_attn_block__sliding_block__prompt_kernel_last-concat_heads__linear_attn_block__sliding_block__prompt_kernel, v12
    v_mov_b32 v13, s5
    s_and_saveexec_b64 s[6:7], vcc
    s_cbranch_execz cpt_1_x
    v_add_co_u32 v12, vcc, s4, v12
    s_nop 1
    v_addc_co_u32 v13, vcc, 0, v13, vcc
    global_load_dword v245, v[12:13], off
cpt_1_x:
    s_mov_b64 exec, s[6:7]
cpt_1:
    v_lshrrev_b32 v2, 6, v0
    v_and_b32 v1, 63, v0
    s_and_b32 s24, s2, 7
    v_readfirstlane_b32 s20, v2
    s_lshr_b32 s25, s2, 3
    s_and_b32 s21, s24, 1
    s_lshr_b32 s24, s24, 1
    s_mov_b32 s78, s21
    s_lshl_b32 s76, s24, 2
    s_and_b32 s77, s25, 3
    s_add_u32 s76, s76, s77
    s_lshr_b32 s77, s25, 2
    s_and_b32 s22, s24, 1
    s_lshl_b32 s22, s22, 3
    s_lshr_b32 s23, s24, 1
    s_lshl_b32 s23, s23, 2
    s_and_b32 s24, s25, 7
    s_add_u32 s22, s22, s24
    s_lshr_b32 s24, s25, 3
    s_add_u32 s23, s23, s24
    s_mov_b32 s75, s20
    s_mov_b32 s83, 0
    s_sub_u32 s26, s20, 4
    v_lshrrev_b32 v2, 3, v1
    v_and_b32 v3, 7, v1
    v_lshrrev_b32 v4, 1, v2
    s_and_b32 s24, s26, 1
    s_lshl_b32 s24, s24, 2
    v_or_b32 v4, s24, v4
    v_xor_b32 v4, v4, v3
    v_lshlrev_b32 v5, 10, v2
    v_lshl_add_u32 v5, v4, 4, v5
    v_bfe_u32 v4, v1, 4, 1
    v_lshlrev_b32 v4, 2, v4
    v_xor_b32 v4, v4, v3
    v_mul_u32_u24 v6, 3072, v2
    v_lshl_add_u32 v6, v4, 4, v6
    v_lshlrev_b32 v7, 10, v2
    v_lshl_add_u32 v7, v4, 4, v7
    s_lshl_b32 s27, s22, 17
    s_lshl_b32 s24, s26, 13
    s_add_u32 s27, s27, s24
    s_lshl_b32 s38, s23, 7
    s_mul_i32 s24, s26, 24576
    s_add_u32 s38, s38, s24
    s_lshl_b32 s39, s26, 10
    s_mov_b32 s40, 0
    s_lshr_b32 s24, s22, 0
    s_and_b32 s24, s24, 7
    s_mul_i32 s24, s24, 1
    s_add_u32 s40, s40, s24
    s_lshr_b32 s24, s23, 0
    s_and_b32 s24, s24, 1
    s_mul_i32 s24, s24, 4
    s_add_u32 s40, s40, s24
    s_mov_b32 s10, 0x200000
    s_mov_b32 s11, 0x20000
    s_mov_b32 s14, 0x180000
    s_mov_b32 s15, 0x20000
    s_mov_b32 s18, 13631488
    s_mov_b32 s19, 0x20000
    s_cmp_eq_u32 s21, 0
    s_waitcnt lgkmcnt(0)
    s_cselect_b32 s8, s28, s32
    s_cselect_b32 s9, s29, s33
    s_cselect_b32 s12, s30, s34
    s_cselect_b32 s13, s31, s35
    s_mov_b32 s16, s72
    s_mov_b32 s17, s73
    s_cmp_lt_u32 s20, 4
    s_cbranch_scc1 concat_heads__linear_attn_block__sliding_block__prompt_kernel_compute
concat_heads__linear_attn_block__sliding_block__prompt_kernel_loader:
    s_add_u32 s24, s40, 0
    s_and_b32 s24, s24, 7
    s_lshl_b32 s41, s24, 7
    s_add_u32 s41, s41, s27
    s_mul_i32 s42, s24, 196608
    s_add_u32 s42, s42, s38
    s_add_u32 m0, s39, 0
    s_add_u32 s24, s41, 0
    buffer_load_dwordx4 v5, s[8:11], s24 offen  lds
    s_add_u32 m0, s39, 4096
    s_add_u32 s24, s41, 32768
    buffer_load_dwordx4 v5, s[8:11], s24 offen  lds
    s_add_u32 m0, s39, 8192
    s_add_u32 s24, s41, 65536
    buffer_load_dwordx4 v5, s[8:11], s24 offen  lds
    s_add_u32 m0, s39, 12288
    s_add_u32 s24, s41, 98304
    buffer_load_dwordx4 v5, s[8:11], s24 offen  lds
    s_add_u32 m0, s39, 49152
    s_add_u32 s24, s42, 0
    buffer_load_dwordx4 v6, s[12:15], s24 offen  lds
    s_add_u32 m0, s39, 57344
    s_add_u32 s24, s42, 1024
    buffer_load_dwordx4 v6, s[12:15], s24 offen  lds
    s_add_u32 m0, s39, 65536
    s_add_u32 s24, s42, 2048
    buffer_load_dwordx4 v6, s[12:15], s24 offen  lds
    s_add_u32 m0, s39, 53248
    s_add_u32 s24, s42, 98304
    buffer_load_dwordx4 v6, s[12:15], s24 offen  lds
    s_add_u32 m0, s39, 61440
    s_add_u32 s24, s42, 99328
    buffer_load_dwordx4 v6, s[12:15], s24 offen  lds
    s_add_u32 m0, s39, 69632
    s_add_u32 s24, s42, 100352
    buffer_load_dwordx4 v6, s[12:15], s24 offen  lds
    s_mov_b32 s4, 13244416
    v_mov_b32 v30, 0
    buffer_load_dword v31, v30, s[16:19], s4 offen sc1
    s_add_u32 s24, s40, 1
    s_and_b32 s24, s24, 7
    s_lshl_b32 s41, s24, 7
    s_add_u32 s41, s41, s27
    s_mul_i32 s42, s24, 196608
    s_add_u32 s42, s42, s38
    s_add_u32 m0, s39, 16384
    s_add_u32 s24, s41, 0
    buffer_load_dwordx4 v5, s[8:11], s24 offen  lds
    s_add_u32 m0, s39, 20480
    s_add_u32 s24, s41, 32768
    buffer_load_dwordx4 v5, s[8:11], s24 offen  lds
    s_add_u32 m0, s39, 24576
    s_add_u32 s24, s41, 65536
    buffer_load_dwordx4 v5, s[8:11], s24 offen  lds
    s_waitcnt vmcnt(3)
    v_readfirstlane_b32 s74, v31
    s_nop 3
    s_add_u32 s74, s74, 1
    s_barrier
    s_add_u32 m0, s39, 28672
    s_add_u32 s24, s41, 98304
    buffer_load_dwordx4 v5, s[8:11], s24 offen  lds
    s_add_u32 m0, s39, 73728
    s_add_u32 s24, s42, 0
    buffer_load_dwordx4 v6, s[12:15], s24 offen  lds
    s_add_u32 m0, s39, 81920
    s_add_u32 s24, s42, 1024
    buffer_load_dwordx4 v6, s[12:15], s24 offen  lds
    s_add_u32 m0, s39, 90112
    s_add_u32 s24, s42, 2048
    buffer_load_dwordx4 v6, s[12:15], s24 offen  lds
    s_add_u32 m0, s39, 77824
    s_add_u32 s24, s42, 98304
    buffer_load_dwordx4 v6, s[12:15], s24 offen  lds
    s_add_u32 m0, s39, 86016
    s_add_u32 s24, s42, 99328
    buffer_load_dwordx4 v6, s[12:15], s24 offen  lds
    s_add_u32 m0, s39, 94208
    s_add_u32 s24, s42, 100352
    buffer_load_dwordx4 v6, s[12:15], s24 offen  lds
    s_add_u32 s24, s40, 2
    s_and_b32 s24, s24, 7
    s_lshl_b32 s41, s24, 7
    s_add_u32 s41, s41, s27
    s_mul_i32 s42, s24, 196608
    s_add_u32 s42, s42, s38
    s_add_u32 m0, s39, 32768
    s_add_u32 s24, s41, 0
    buffer_load_dwordx4 v5, s[8:11], s24 offen  lds
    s_add_u32 m0, s39, 36864
    s_add_u32 s24, s41, 32768
    buffer_load_dwordx4 v5, s[8:11], s24 offen  lds
    s_add_u32 m0, s39, 40960
    s_add_u32 s24, s41, 65536
    buffer_load_dwordx4 v5, s[8:11], s24 offen  lds
    s_add_u32 m0, s39, 45056
    s_add_u32 s24, s41, 98304
    buffer_load_dwordx4 v5, s[8:11], s24 offen  lds
    s_add_u32 m0, s39, 98304
    s_add_u32 s24, s42, 0
    buffer_load_dwordx4 v6, s[12:15], s24 offen  lds
    s_add_u32 m0, s39, 106496
    s_add_u32 s24, s42, 1024
    buffer_load_dwordx4 v6, s[12:15], s24 offen  lds
    s_add_u32 m0, s39, 114688
    s_add_u32 s24, s42, 2048
    buffer_load_dwordx4 v6, s[12:15], s24 offen  lds
    s_add_u32 m0, s39, 102400
    s_add_u32 s24, s42, 98304
    buffer_load_dwordx4 v6, s[12:15], s24 offen  lds
    s_add_u32 m0, s39, 110592
    s_add_u32 s24, s42, 99328
    buffer_load_dwordx4 v6, s[12:15], s24 offen  lds
    s_add_u32 m0, s39, 118784
    s_add_u32 s24, s42, 100352
    buffer_load_dwordx4 v6, s[12:15], s24 offen  lds
    s_waitcnt vmcnt(10)
    s_barrier
    s_add_u32 s24, s40, 3
    s_and_b32 s24, s24, 7
    s_lshl_b32 s41, s24, 7
    s_add_u32 s41, s41, s27
    s_mul_i32 s42, s24, 196608
    s_add_u32 s42, s42, s38
    s_add_u32 m0, s39, 0
    s_add_u32 s24, s41, 0
    buffer_load_dwordx4 v5, s[8:11], s24 offen  lds
    s_add_u32 m0, s39, 4096
    s_add_u32 s24, s41, 32768
    buffer_load_dwordx4 v5, s[8:11], s24 offen  lds
    s_add_u32 m0, s39, 8192
    s_add_u32 s24, s41, 65536
    buffer_load_dwordx4 v5, s[8:11], s24 offen  lds
    s_add_u32 m0, s39, 12288
    s_add_u32 s24, s41, 98304
    buffer_load_dwordx4 v5, s[8:11], s24 offen  lds
    s_add_u32 m0, s39, 49152
    s_add_u32 s24, s42, 0
    buffer_load_dwordx4 v6, s[12:15], s24 offen  lds
    s_add_u32 m0, s39, 57344
    s_add_u32 s24, s42, 1024
    buffer_load_dwordx4 v6, s[12:15], s24 offen  lds
    s_add_u32 m0, s39, 65536
    s_add_u32 s24, s42, 2048
    buffer_load_dwordx4 v6, s[12:15], s24 offen  lds
    s_add_u32 m0, s39, 53248
    s_add_u32 s24, s42, 98304
    buffer_load_dwordx4 v6, s[12:15], s24 offen  lds
    s_add_u32 m0, s39, 61440
    s_add_u32 s24, s42, 99328
    buffer_load_dwordx4 v6, s[12:15], s24 offen  lds
    s_add_u32 m0, s39, 69632
    s_add_u32 s24, s42, 100352
    buffer_load_dwordx4 v6, s[12:15], s24 offen  lds
    s_waitcnt vmcnt(10)
    s_barrier
    s_add_u32 s24, s40, 4
    s_and_b32 s24, s24, 7
    s_lshl_b32 s41, s24, 7
    s_add_u32 s41, s41, s27
    s_mul_i32 s42, s24, 196608
    s_add_u32 s42, s42, s38
    s_add_u32 m0, s39, 16384
    s_add_u32 s24, s41, 0
    buffer_load_dwordx4 v5, s[8:11], s24 offen  lds
    s_add_u32 m0, s39, 20480
    s_add_u32 s24, s41, 32768
    buffer_load_dwordx4 v5, s[8:11], s24 offen  lds
    s_add_u32 m0, s39, 24576
    s_add_u32 s24, s41, 65536
    buffer_load_dwordx4 v5, s[8:11], s24 offen  lds
    s_add_u32 m0, s39, 28672
    s_add_u32 s24, s41, 98304
    buffer_load_dwordx4 v5, s[8:11], s24 offen  lds
    s_add_u32 m0, s39, 73728
    s_add_u32 s24, s42, 0
    buffer_load_dwordx4 v6, s[12:15], s24 offen  lds
    s_add_u32 m0, s39, 81920
    s_add_u32 s24, s42, 1024
    buffer_load_dwordx4 v6, s[12:15], s24 offen  lds
    s_add_u32 m0, s39, 90112
    s_add_u32 s24, s42, 2048
    buffer_load_dwordx4 v6, s[12:15], s24 offen  lds
    s_add_u32 m0, s39, 77824
    s_add_u32 s24, s42, 98304
    buffer_load_dwordx4 v6, s[12:15], s24 offen  lds
    s_add_u32 m0, s39, 86016
    s_add_u32 s24, s42, 99328
    buffer_load_dwordx4 v6, s[12:15], s24 offen  lds
    s_add_u32 m0, s39, 94208
    s_add_u32 s24, s42, 100352
    buffer_load_dwordx4 v6, s[12:15], s24 offen  lds
    s_waitcnt vmcnt(10)
    s_barrier
    s_add_u32 s24, s40, 5
    s_and_b32 s24, s24, 7
    s_lshl_b32 s41, s24, 7
    s_add_u32 s41, s41, s27
    s_mul_i32 s42, s24, 196608
    s_add_u32 s42, s42, s38
    s_add_u32 m0, s39, 32768
    s_add_u32 s24, s41, 0
    buffer_load_dwordx4 v5, s[8:11], s24 offen  lds
    s_add_u32 m0, s39, 36864
    s_add_u32 s24, s41, 32768
    buffer_load_dwordx4 v5, s[8:11], s24 offen  lds
    s_add_u32 m0, s39, 40960
    s_add_u32 s24, s41, 65536
    buffer_load_dwordx4 v5, s[8:11], s24 offen  lds
    s_add_u32 m0, s39, 45056
    s_add_u32 s24, s41, 98304
    buffer_load_dwordx4 v5, s[8:11], s24 offen  lds
    s_add_u32 m0, s39, 98304
    s_add_u32 s24, s42, 0
    buffer_load_dwordx4 v6, s[12:15], s24 offen  lds
    s_add_u32 m0, s39, 106496
    s_add_u32 s24, s42, 1024
    buffer_load_dwordx4 v6, s[12:15], s24 offen  lds
    s_add_u32 m0, s39, 114688
    s_add_u32 s24, s42, 2048
    buffer_load_dwordx4 v6, s[12:15], s24 offen  lds
    s_add_u32 m0, s39, 102400
    s_add_u32 s24, s42, 98304
    buffer_load_dwordx4 v6, s[12:15], s24 offen  lds
    s_add_u32 m0, s39, 110592
    s_add_u32 s24, s42, 99328
    buffer_load_dwordx4 v6, s[12:15], s24 offen  lds
    s_add_u32 m0, s39, 118784
    s_add_u32 s24, s42, 100352
    buffer_load_dwordx4 v6, s[12:15], s24 offen  lds
    s_waitcnt vmcnt(10)
    s_barrier
    s_add_u32 s24, s40, 6
    s_and_b32 s24, s24, 7
    s_lshl_b32 s41, s24, 7
    s_add_u32 s41, s41, s27
    s_mul_i32 s42, s24, 196608
    s_add_u32 s42, s42, s38
    s_add_u32 m0, s39, 0
    s_add_u32 s24, s41, 0
    buffer_load_dwordx4 v5, s[8:11], s24 offen  lds
    s_add_u32 m0, s39, 4096
    s_add_u32 s24, s41, 32768
    buffer_load_dwordx4 v5, s[8:11], s24 offen  lds
    s_add_u32 m0, s39, 8192
    s_add_u32 s24, s41, 65536
    buffer_load_dwordx4 v5, s[8:11], s24 offen  lds
    s_add_u32 m0, s39, 12288
    s_add_u32 s24, s41, 98304
    buffer_load_dwordx4 v5, s[8:11], s24 offen  lds
    s_add_u32 m0, s39, 49152
    s_add_u32 s24, s42, 0
    buffer_load_dwordx4 v6, s[12:15], s24 offen  lds
    s_add_u32 m0, s39, 57344
    s_add_u32 s24, s42, 1024
    buffer_load_dwordx4 v6, s[12:15], s24 offen  lds
    s_add_u32 m0, s39, 65536
    s_add_u32 s24, s42, 2048
    buffer_load_dwordx4 v6, s[12:15], s24 offen  lds
    s_add_u32 m0, s39, 53248
    s_add_u32 s24, s42, 98304
    buffer_load_dwordx4 v6, s[12:15], s24 offen  lds
    s_add_u32 m0, s39, 61440
    s_add_u32 s24, s42, 99328
    buffer_load_dwordx4 v6, s[12:15], s24 offen  lds
    s_add_u32 m0, s39, 69632
    s_add_u32 s24, s42, 100352
    buffer_load_dwordx4 v6, s[12:15], s24 offen  lds
    s_waitcnt vmcnt(10)
    s_barrier
    s_add_u32 s24, s40, 7
    s_and_b32 s24, s24, 7
    s_lshl_b32 s41, s24, 7
    s_add_u32 s41, s41, s27
    s_mul_i32 s42, s24, 196608
    s_add_u32 s42, s42, s38
    s_add_u32 m0, s39, 16384
    s_add_u32 s24, s41, 0
    buffer_load_dwordx4 v5, s[8:11], s24 offen  lds
    s_add_u32 m0, s39, 20480
    s_add_u32 s24, s41, 32768
    buffer_load_dwordx4 v5, s[8:11], s24 offen  lds
    s_add_u32 m0, s39, 24576
    s_add_u32 s24, s41, 65536
    buffer_load_dwordx4 v5, s[8:11], s24 offen  lds
    s_add_u32 m0, s39, 28672
    s_add_u32 s24, s41, 98304
    buffer_load_dwordx4 v5, s[8:11], s24 offen  lds
    s_add_u32 m0, s39, 73728
    s_add_u32 s24, s42, 0
    buffer_load_dwordx4 v6, s[12:15], s24 offen  lds
    s_add_u32 m0, s39, 81920
    s_add_u32 s24, s42, 1024
    buffer_load_dwordx4 v6, s[12:15], s24 offen  lds
    s_add_u32 m0, s39, 90112
    s_add_u32 s24, s42, 2048
    buffer_load_dwordx4 v6, s[12:15], s24 offen  lds
    s_add_u32 m0, s39, 77824
    s_add_u32 s24, s42, 98304
    buffer_load_dwordx4 v6, s[12:15], s24 offen  lds
    s_add_u32 m0, s39, 86016
    s_add_u32 s24, s42, 99328
    buffer_load_dwordx4 v6, s[12:15], s24 offen  lds
    s_add_u32 m0, s39, 94208
    s_add_u32 s24, s42, 100352
    buffer_load_dwordx4 v6, s[12:15], s24 offen  lds
    s_waitcnt vmcnt(10)
    s_barrier
    s_cmp_eq_u32 s78, 0
    s_cselect_b32 s28, s64, s66
    s_cselect_b32 s29, s65, s67
    s_mov_b32 s30, 0x80000
    s_mov_b32 s31, 0x20000
    s_lshl_b32 s41, s77, 7
    s_lshl_b32 s24, s26, 13
    s_add_u32 s41, s41, s24
    v_and_b32 v8, 31, v1
    s_lshl_b32 s24, s26, 5
    v_add_u32 v8, s24, v8
    v_lshlrev_b32 v8, 10, v8
    s_and_b32 s24, s76, 3
    s_lshl_b32 s24, s24, 17
    s_lshl_b32 s41, s77, 7
    s_add_u32 s24, s24, s41
    buffer_load_dword v244, v8, s[28:31], s24 offen
    s_waitcnt vmcnt(1)
    s_barrier
    s_cmp_eq_u32 s21, 1
    s_cbranch_scc1 concat_heads__linear_attn_block__sliding_block__prompt_kernel_p1bar
    s_barrier
    s_branch concat_heads__linear_attn_block__sliding_block__prompt_kernel_p1bar
concat_heads__linear_attn_block__sliding_block__prompt_kernel_compute:
    s_mov_b32 s4, 13244416
    v_mov_b32 v30, 0
    buffer_load_dword v31, v30, s[16:19], s4 offen sc1
    s_and_b32 s26, s20, 1
    s_lshr_b32 s27, s20, 1
    v_lshrrev_b32 v2, 5, v1
    v_and_b32 v3, 31, v1
    v_lshrrev_b32 v9, 1, v3
    v_and_b32 v9, 7, v9
    s_lshl_b32 s24, s26, 13
    v_lshlrev_b32 v10, 7, v3
    v_add_u32 v10, s24, v10
    v_or_b32 v11, 0, v2
    v_xor_b32 v11, v11, v9
    v_lshl_add_u32 v4, v11, 4, v10
    v_or_b32 v11, 2, v2
    v_xor_b32 v11, v11, v9
    v_lshl_add_u32 v5, v11, 4, v10
    v_or_b32 v11, 4, v2
    v_xor_b32 v11, v11, v9
    v_lshl_add_u32 v6, v11, 4, v10
    v_or_b32 v11, 6, v2
    v_xor_b32 v11, v11, v9
    v_lshl_add_u32 v7, v11, 4, v10
    v_bfe_u32 v10, v1, 2, 2
    v_lshlrev_b32 v10, 7, v10
    v_lshl_add_u32 v10, v2, 10, v10
    v_bfe_u32 v11, v1, 4, 1
    v_lshlrev_b32 v11, 1, v11
    v_bfe_u32 v12, v1, 1, 1
    v_or_b32 v11, v11, v12
    s_lshl_b32 s24, s27, 2
    v_or_b32 v11, s24, v11
    v_bfe_u32 v12, v1, 3, 1
    v_lshlrev_b32 v12, 2, v12
    v_xor_b32 v11, v11, v12
    v_lshl_add_u32 v10, v11, 4, v10
    v_and_b32 v12, 1, v1
    v_lshl_add_u32 v10, v12, 3, v10
    v_add_u32 v8, 49152, v10
    v_mov_b32 v32, 0
    v_mov_b32 v33, 0
    v_mov_b32 v34, 0
    v_mov_b32 v35, 0
    v_mov_b32 v36, 0
    v_mov_b32 v37, 0
    v_mov_b32 v38, 0
    v_mov_b32 v39, 0
    v_mov_b32 v40, 0
    v_mov_b32 v41, 0
    v_mov_b32 v42, 0
    v_mov_b32 v43, 0
    v_mov_b32 v44, 0
    v_mov_b32 v45, 0
    v_mov_b32 v46, 0
    v_mov_b32 v47, 0
    v_mov_b32 v48, 0
    v_mov_b32 v49, 0
    v_mov_b32 v50, 0
    v_mov_b32 v51, 0
    v_mov_b32 v52, 0
    v_mov_b32 v53, 0
    v_mov_b32 v54, 0
    v_mov_b32 v55, 0
    v_mov_b32 v56, 0
    v_mov_b32 v57, 0
    v_mov_b32 v58, 0
    v_mov_b32 v59, 0
    v_mov_b32 v60, 0
    v_mov_b32 v61, 0
    v_mov_b32 v62, 0
    v_mov_b32 v63, 0
    v_mov_b32 v64, 0
    v_mov_b32 v65, 0
    v_mov_b32 v66, 0
    v_mov_b32 v67, 0
    v_mov_b32 v68, 0
    v_mov_b32 v69, 0
    v_mov_b32 v70, 0
    v_mov_b32 v71, 0
    v_mov_b32 v72, 0
    v_mov_b32 v73, 0
    v_mov_b32 v74, 0
    v_mov_b32 v75, 0
    v_mov_b32 v76, 0
    v_mov_b32 v77, 0
    v_mov_b32 v78, 0
    v_mov_b32 v79, 0
    v_mov_b32 v80, 0
    v_mov_b32 v81, 0
    v_mov_b32 v82, 0
    v_mov_b32 v83, 0
    v_mov_b32 v84, 0
    v_mov_b32 v85, 0
    v_mov_b32 v86, 0
    v_mov_b32 v87, 0
    v_mov_b32 v88, 0
    v_mov_b32 v89, 0
    v_mov_b32 v90, 0
    v_mov_b32 v91, 0
    v_mov_b32 v92, 0
    v_mov_b32 v93, 0
    v_mov_b32 v94, 0
    v_mov_b32 v95, 0
    v_mov_b32 v96, 0
    v_mov_b32 v97, 0
    v_mov_b32 v98, 0
    v_mov_b32 v99, 0
    v_mov_b32 v100, 0
    v_mov_b32 v101, 0
    v_mov_b32 v102, 0
    v_mov_b32 v103, 0
    v_mov_b32 v104, 0
    v_mov_b32 v105, 0
    v_mov_b32 v106, 0
    v_mov_b32 v107, 0
    v_mov_b32 v108, 0
    v_mov_b32 v109, 0
    v_mov_b32 v110, 0
    v_mov_b32 v111, 0
    v_mov_b32 v112, 0
    v_mov_b32 v113, 0
    v_mov_b32 v114, 0
    v_mov_b32 v115, 0
    v_mov_b32 v116, 0
    v_mov_b32 v117, 0
    v_mov_b32 v118, 0
    v_mov_b32 v119, 0
    v_mov_b32 v120, 0
    v_mov_b32 v121, 0
    v_mov_b32 v122, 0
    v_mov_b32 v123, 0
    v_mov_b32 v124, 0
    v_mov_b32 v125, 0
    v_mov_b32 v126, 0
    v_mov_b32 v127, 0
    s_mov_b32 s58, 0xffff8000
    s_mov_b32 s59, 16384
    s_mov_b32 s60, 0xffff4000
    s_mov_b32 s61, 24576
    s_cmp_eq_u32 s21, 1
    s_cbranch_scc1 concat_heads__linear_attn_block__sliding_block__prompt_kernel_cB
    s_mov_b32 s38, 0
    s_mov_b32 s39, 0
    s_waitcnt vmcnt(0)
    v_readfirstlane_b32 s74, v31
    s_nop 3
    s_add_u32 s74, s74, 1
    s_barrier
    ds_read_b128 v[128:131], v4
    ds_read_b64_tr_b16 v[136:137], v8 offset:0
    ds_read_b64_tr_b16 v[138:139], v8 offset:512
    ds_read_b128 v[132:135], v4 offset:4096
    ds_read_b64_tr_b16 v[140:141], v8 offset:8192
    ds_read_b64_tr_b16 v[142:143], v8 offset:8704
    ds_read_b64_tr_b16 v[144:145], v8 offset:16384
    ds_read_b64_tr_b16 v[146:147], v8 offset:16896
concat_heads__linear_attn_block__sliding_block__prompt_kernel_loopA:
    s_waitcnt lgkmcnt(0)
    v_mfma_f32_32x32x16_bf16 v[32:47], v[136:139], v[128:131], v[32:47]
    ds_read_b128 v[148:151], v5
    ds_read_b64_tr_b16 v[156:157], v8 offset:2048
    ds_read_b64_tr_b16 v[158:159], v8 offset:2560
    v_mfma_f32_32x32x16_bf16 v[80:95], v[136:139], v[132:135], v[80:95]
    ds_read_b128 v[152:155], v5 offset:4096
    ds_read_b64_tr_b16 v[160:161], v8 offset:10240
    ds_read_b64_tr_b16 v[162:163], v8 offset:10752
    v_mfma_f32_32x32x16_bf16 v[48:63], v[128:131], v[140:143], v[48:63]
    ds_read_b64_tr_b16 v[164:165], v8 offset:18432
    ds_read_b64_tr_b16 v[166:167], v8 offset:18944
    v_mfma_f32_32x32x16_bf16 v[96:111], v[132:135], v[140:143], v[96:111]
    v_mfma_f32_32x32x16_bf16 v[64:79], v[128:131], v[144:147], v[64:79]
    v_mfma_f32_32x32x16_bf16 v[112:127], v[132:135], v[144:147], v[112:127]
    s_waitcnt lgkmcnt(0)
    v_mfma_f32_32x32x16_bf16 v[32:47], v[156:159], v[148:151], v[32:47]
    ds_read_b128 v[128:131], v6
    ds_read_b64_tr_b16 v[136:137], v8 offset:4096
    ds_read_b64_tr_b16 v[138:139], v8 offset:4608
    v_mfma_f32_32x32x16_bf16 v[80:95], v[156:159], v[152:155], v[80:95]
    ds_read_b128 v[132:135], v6 offset:4096
    ds_read_b64_tr_b16 v[140:141], v8 offset:12288
    ds_read_b64_tr_b16 v[142:143], v8 offset:12800
    v_mfma_f32_32x32x16_bf16 v[48:63], v[148:151], v[160:163], v[48:63]
    ds_read_b64_tr_b16 v[144:145], v8 offset:20480
    ds_read_b64_tr_b16 v[146:147], v8 offset:20992
    v_mfma_f32_32x32x16_bf16 v[96:111], v[152:155], v[160:163], v[96:111]
    v_mfma_f32_32x32x16_bf16 v[64:79], v[148:151], v[164:167], v[64:79]
    v_mfma_f32_32x32x16_bf16 v[112:127], v[152:155], v[164:167], v[112:127]
    s_waitcnt lgkmcnt(0)
    v_mfma_f32_32x32x16_bf16 v[32:47], v[136:139], v[128:131], v[32:47]
    ds_read_b128 v[148:151], v7
    ds_read_b64_tr_b16 v[156:157], v8 offset:6144
    ds_read_b64_tr_b16 v[158:159], v8 offset:6656
    v_mfma_f32_32x32x16_bf16 v[80:95], v[136:139], v[132:135], v[80:95]
    ds_read_b128 v[152:155], v7 offset:4096
    ds_read_b64_tr_b16 v[160:161], v8 offset:14336
    ds_read_b64_tr_b16 v[162:163], v8 offset:14848
    v_mfma_f32_32x32x16_bf16 v[48:63], v[128:131], v[140:143], v[48:63]
    ds_read_b64_tr_b16 v[164:165], v8 offset:22528
    ds_read_b64_tr_b16 v[166:167], v8 offset:23040
    v_mfma_f32_32x32x16_bf16 v[96:111], v[132:135], v[140:143], v[96:111]
    v_mfma_f32_32x32x16_bf16 v[64:79], v[128:131], v[144:147], v[64:79]
    v_mfma_f32_32x32x16_bf16 v[112:127], v[132:135], v[144:147], v[112:127]
    s_add_u32 s39, s39, 1
    s_cmp_eq_u32 s39, 3
    s_cselect_b32 s40, s58, s59
    s_cselect_b32 s41, s60, s61
    s_cselect_b32 s39, 0, s39
    s_waitcnt lgkmcnt(0)
    s_barrier
    v_add_u32 v4, s40, v4
    v_add_u32 v5, s40, v5
    v_add_u32 v6, s40, v6
    v_add_u32 v7, s40, v7
    v_add_u32 v8, s41, v8
    v_mfma_f32_32x32x16_bf16 v[32:47], v[156:159], v[148:151], v[32:47]
    ds_read_b128 v[128:131], v4
    ds_read_b64_tr_b16 v[136:137], v8 offset:0
    ds_read_b64_tr_b16 v[138:139], v8 offset:512
    v_mfma_f32_32x32x16_bf16 v[80:95], v[156:159], v[152:155], v[80:95]
    ds_read_b128 v[132:135], v4 offset:4096
    ds_read_b64_tr_b16 v[140:141], v8 offset:8192
    ds_read_b64_tr_b16 v[142:143], v8 offset:8704
    v_mfma_f32_32x32x16_bf16 v[48:63], v[148:151], v[160:163], v[48:63]
    ds_read_b64_tr_b16 v[144:145], v8 offset:16384
    ds_read_b64_tr_b16 v[146:147], v8 offset:16896
    v_mfma_f32_32x32x16_bf16 v[96:111], v[152:155], v[160:163], v[96:111]
    v_mfma_f32_32x32x16_bf16 v[64:79], v[148:151], v[164:167], v[64:79]
    v_mfma_f32_32x32x16_bf16 v[112:127], v[152:155], v[164:167], v[112:127]
    s_add_u32 s38, s38, 1
    s_cmp_lt_u32 s38, 7
    s_cbranch_scc1 concat_heads__linear_attn_block__sliding_block__prompt_kernel_loopA
    s_waitcnt lgkmcnt(0)
    v_mfma_f32_32x32x16_bf16 v[32:47], v[136:139], v[128:131], v[32:47]
    ds_read_b128 v[148:151], v5
    ds_read_b64_tr_b16 v[156:157], v8 offset:2048
    ds_read_b64_tr_b16 v[158:159], v8 offset:2560
    v_mfma_f32_32x32x16_bf16 v[80:95], v[136:139], v[132:135], v[80:95]
    ds_read_b128 v[152:155], v5 offset:4096
    ds_read_b64_tr_b16 v[160:161], v8 offset:10240
    ds_read_b64_tr_b16 v[162:163], v8 offset:10752
    v_mfma_f32_32x32x16_bf16 v[48:63], v[128:131], v[140:143], v[48:63]
    ds_read_b64_tr_b16 v[164:165], v8 offset:18432
    ds_read_b64_tr_b16 v[166:167], v8 offset:18944
    v_mfma_f32_32x32x16_bf16 v[96:111], v[132:135], v[140:143], v[96:111]
    v_mfma_f32_32x32x16_bf16 v[64:79], v[128:131], v[144:147], v[64:79]
    v_mfma_f32_32x32x16_bf16 v[112:127], v[132:135], v[144:147], v[112:127]
    s_waitcnt lgkmcnt(0)
    v_mfma_f32_32x32x16_bf16 v[32:47], v[156:159], v[148:151], v[32:47]
    ds_read_b128 v[128:131], v6
    ds_read_b64_tr_b16 v[136:137], v8 offset:4096
    ds_read_b64_tr_b16 v[138:139], v8 offset:4608
    v_mfma_f32_32x32x16_bf16 v[80:95], v[156:159], v[152:155], v[80:95]
    ds_read_b128 v[132:135], v6 offset:4096
    ds_read_b64_tr_b16 v[140:141], v8 offset:12288
    ds_read_b64_tr_b16 v[142:143], v8 offset:12800
    v_mfma_f32_32x32x16_bf16 v[48:63], v[148:151], v[160:163], v[48:63]
    ds_read_b64_tr_b16 v[144:145], v8 offset:20480
    ds_read_b64_tr_b16 v[146:147], v8 offset:20992
    v_mfma_f32_32x32x16_bf16 v[96:111], v[152:155], v[160:163], v[96:111]
    v_mfma_f32_32x32x16_bf16 v[64:79], v[148:151], v[164:167], v[64:79]
    v_mfma_f32_32x32x16_bf16 v[112:127], v[152:155], v[164:167], v[112:127]
    s_waitcnt lgkmcnt(0)
    v_mfma_f32_32x32x16_bf16 v[32:47], v[136:139], v[128:131], v[32:47]
    ds_read_b128 v[148:151], v7
    ds_read_b64_tr_b16 v[156:157], v8 offset:6144
    ds_read_b64_tr_b16 v[158:159], v8 offset:6656
    v_mfma_f32_32x32x16_bf16 v[80:95], v[136:139], v[132:135], v[80:95]
    ds_read_b128 v[152:155], v7 offset:4096
    ds_read_b64_tr_b16 v[160:161], v8 offset:14336
    ds_read_b64_tr_b16 v[162:163], v8 offset:14848
    v_mfma_f32_32x32x16_bf16 v[48:63], v[128:131], v[140:143], v[48:63]
    ds_read_b64_tr_b16 v[164:165], v8 offset:22528
    ds_read_b64_tr_b16 v[166:167], v8 offset:23040
    v_mfma_f32_32x32x16_bf16 v[96:111], v[132:135], v[140:143], v[96:111]
    v_mfma_f32_32x32x16_bf16 v[64:79], v[128:131], v[144:147], v[64:79]
    v_mfma_f32_32x32x16_bf16 v[112:127], v[132:135], v[144:147], v[112:127]
    s_waitcnt lgkmcnt(0)
    v_mfma_f32_32x32x16_bf16 v[32:47], v[156:159], v[148:151], v[32:47]
    v_mfma_f32_32x32x16_bf16 v[80:95], v[156:159], v[152:155], v[80:95]
    v_mfma_f32_32x32x16_bf16 v[48:63], v[148:151], v[160:163], v[48:63]
    v_mfma_f32_32x32x16_bf16 v[96:111], v[152:155], v[160:163], v[96:111]
    v_mfma_f32_32x32x16_bf16 v[64:79], v[148:151], v[164:167], v[64:79]
    v_mfma_f32_32x32x16_bf16 v[112:127], v[152:155], v[164:167], v[112:127]
    s_lshl_b32 s43, s23, 2
    s_lshl_b32 s24, s27, 1
    s_add_u32 s43, s43, s24
    s_lshl_b32 s44, s22, 2
    s_lshl_b32 s24, s26, 1
    s_add_u32 s44, s44, s24
    s_lshl_b32 s42, s43, 16
    s_lshl_b32 s24, s44, 10
    s_add_u32 s42, s42, s24
    v_lshlrev_b32 v9, 4, v1
    s_mov_b32 s46, 0x3fb8aa3b
    s_mov_b32 s47, 0x3fb8aa3b
    s_mov_b32 s48, 1.0
    s_mov_b32 s49, 1.0
    s_mov_b32 s50, 0x358637bd
    s_mov_b32 s51, 0x358637bd
    s_mov_b32 s52, 0x0000ffff
    s_mov_b32 s53, 0x0000ffff
    v_mov_b32 v20, 0x3f803f80
    v_mov_b32 v21, 0x3f803f80
    v_mov_b32 v22, 0x3f803f80
    v_mov_b32 v23, 0x3f803f80
    s_nop 4
    v_cvt_pk_bf16_f32 v144, v64, v65
    v_cvt_pk_bf16_f32 v145, v66, v67
    v_cvt_pk_bf16_f32 v146, v68, v69
    v_cvt_pk_bf16_f32 v147, v70, v71
    v_cvt_pk_bf16_f32 v148, v72, v73
    v_cvt_pk_bf16_f32 v149, v74, v75
    v_cvt_pk_bf16_f32 v150, v76, v77
    v_cvt_pk_bf16_f32 v151, v78, v79
    v_cvt_pk_bf16_f32 v152, v112, v113
    v_cvt_pk_bf16_f32 v153, v114, v115
    v_cvt_pk_bf16_f32 v154, v116, v117
    v_cvt_pk_bf16_f32 v155, v118, v119
    v_cvt_pk_bf16_f32 v156, v120, v121
    v_cvt_pk_bf16_f32 v157, v122, v123
    v_cvt_pk_bf16_f32 v158, v124, v125
    v_cvt_pk_bf16_f32 v159, v126, v127
    v_pk_mul_f32 v[168:169], v[48:49], s[46:47]
    v_pk_mul_f32 v[170:171], v[50:51], s[46:47]
    v_pk_mul_f32 v[172:173], v[52:53], s[46:47]
    v_pk_mul_f32 v[174:175], v[54:55], s[46:47]
    v_pk_mul_f32 v[176:177], v[56:57], s[46:47]
    v_pk_mul_f32 v[178:179], v[58:59], s[46:47]
    v_pk_mul_f32 v[180:181], v[60:61], s[46:47]
    v_pk_mul_f32 v[182:183], v[62:63], s[46:47]
    v_exp_f32 v168, v168 clamp
    v_exp_f32 v169, v169 clamp
    v_exp_f32 v170, v170 clamp
    v_exp_f32 v171, v171 clamp
    v_exp_f32 v172, v172 clamp
    v_exp_f32 v173, v173 clamp
    v_exp_f32 v174, v174 clamp
    v_exp_f32 v175, v175 clamp
    v_exp_f32 v176, v176 clamp
    v_exp_f32 v177, v177 clamp
    v_exp_f32 v178, v178 clamp
    v_exp_f32 v179, v179 clamp
    v_exp_f32 v180, v180 clamp
    v_exp_f32 v181, v181 clamp
    v_exp_f32 v182, v182 clamp
    v_exp_f32 v183, v183 clamp
    v_pk_add_f32 v[48:49], v[48:49], s[48:49]
    v_pk_add_f32 v[50:51], v[50:51], s[48:49]
    v_pk_add_f32 v[52:53], v[52:53], s[48:49]
    v_pk_add_f32 v[54:55], v[54:55], s[48:49]
    v_pk_add_f32 v[56:57], v[56:57], s[48:49]
    v_pk_add_f32 v[58:59], v[58:59], s[48:49]
    v_pk_add_f32 v[60:61], v[60:61], s[48:49]
    v_pk_add_f32 v[62:63], v[62:63], s[48:49]
    v_max_f32 v48, v48, v168
    v_max_f32 v49, v49, v169
    v_max_f32 v50, v50, v170
    v_max_f32 v51, v51, v171
    v_max_f32 v52, v52, v172
    v_max_f32 v53, v53, v173
    v_max_f32 v54, v54, v174
    v_max_f32 v55, v55, v175
    v_max_f32 v56, v56, v176
    v_max_f32 v57, v57, v177
    v_max_f32 v58, v58, v178
    v_max_f32 v59, v59, v179
    v_max_f32 v60, v60, v180
    v_max_f32 v61, v61, v181
    v_max_f32 v62, v62, v182
    v_max_f32 v63, v63, v183
    v_pk_add_f32 v[48:49], v[48:49], s[50:51]
    v_pk_add_f32 v[50:51], v[50:51], s[50:51]
    v_pk_add_f32 v[52:53], v[52:53], s[50:51]
    v_pk_add_f32 v[54:55], v[54:55], s[50:51]
    v_pk_add_f32 v[56:57], v[56:57], s[50:51]
    v_pk_add_f32 v[58:59], v[58:59], s[50:51]
    v_pk_add_f32 v[60:61], v[60:61], s[50:51]
    v_pk_add_f32 v[62:63], v[62:63], s[50:51]
    v_cvt_pk_bf16_f32 v128, v48, v49
    v_cvt_pk_bf16_f32 v129, v50, v51
    v_cvt_pk_bf16_f32 v130, v52, v53
    v_cvt_pk_bf16_f32 v131, v54, v55
    v_cvt_pk_bf16_f32 v132, v56, v57
    v_cvt_pk_bf16_f32 v133, v58, v59
    v_cvt_pk_bf16_f32 v134, v60, v61
    v_cvt_pk_bf16_f32 v135, v62, v63
    s_nop 1
    v_mfma_f32_32x32x16_bf16 v[184:199], v[128:131], v[144:147], 0
    v_mfma_f32_32x32x16_bf16 v[200:215], v[128:131], v[20:23], 0
    v_mfma_f32_32x32x16_bf16 v[184:199], v[132:135], v[148:151], v[184:199]
    v_mfma_f32_32x32x16_bf16 v[200:215], v[132:135], v[20:23], v[200:215]
    v_pk_mul_f32 v[168:169], v[96:97], s[46:47]
    v_pk_mul_f32 v[170:171], v[98:99], s[46:47]
    v_pk_mul_f32 v[172:173], v[100:101], s[46:47]
    v_pk_mul_f32 v[174:175], v[102:103], s[46:47]
    v_pk_mul_f32 v[176:177], v[104:105], s[46:47]
    v_pk_mul_f32 v[178:179], v[106:107], s[46:47]
    v_pk_mul_f32 v[180:181], v[108:109], s[46:47]
    v_pk_mul_f32 v[182:183], v[110:111], s[46:47]
    v_exp_f32 v168, v168 clamp
    v_exp_f32 v169, v169 clamp
    v_exp_f32 v170, v170 clamp
    v_exp_f32 v171, v171 clamp
    v_exp_f32 v172, v172 clamp
    v_exp_f32 v173, v173 clamp
    v_exp_f32 v174, v174 clamp
    v_exp_f32 v175, v175 clamp
    v_exp_f32 v176, v176 clamp
    v_exp_f32 v177, v177 clamp
    v_exp_f32 v178, v178 clamp
    v_exp_f32 v179, v179 clamp
    v_exp_f32 v180, v180 clamp
    v_exp_f32 v181, v181 clamp
    v_exp_f32 v182, v182 clamp
    v_exp_f32 v183, v183 clamp
    v_pk_add_f32 v[96:97], v[96:97], s[48:49]
    v_pk_add_f32 v[98:99], v[98:99], s[48:49]
    v_pk_add_f32 v[100:101], v[100:101], s[48:49]
    v_pk_add_f32 v[102:103], v[102:103], s[48:49]
    v_pk_add_f32 v[104:105], v[104:105], s[48:49]
    v_pk_add_f32 v[106:107], v[106:107], s[48:49]
    v_pk_add_f32 v[108:109], v[108:109], s[48:49]
    v_pk_add_f32 v[110:111], v[110:111], s[48:49]
    v_max_f32 v96, v96, v168
    v_max_f32 v97, v97, v169
    v_max_f32 v98, v98, v170
    v_max_f32 v99, v99, v171
    v_max_f32 v100, v100, v172
    v_max_f32 v101, v101, v173
    v_max_f32 v102, v102, v174
    v_max_f32 v103, v103, v175
    v_max_f32 v104, v104, v176
    v_max_f32 v105, v105, v177
    v_max_f32 v106, v106, v178
    v_max_f32 v107, v107, v179
    v_max_f32 v108, v108, v180
    v_max_f32 v109, v109, v181
    v_max_f32 v110, v110, v182
    v_max_f32 v111, v111, v183
    v_pk_add_f32 v[96:97], v[96:97], s[50:51]
    v_pk_add_f32 v[98:99], v[98:99], s[50:51]
    v_pk_add_f32 v[100:101], v[100:101], s[50:51]
    v_pk_add_f32 v[102:103], v[102:103], s[50:51]
    v_pk_add_f32 v[104:105], v[104:105], s[50:51]
    v_pk_add_f32 v[106:107], v[106:107], s[50:51]
    v_pk_add_f32 v[108:109], v[108:109], s[50:51]
    v_pk_add_f32 v[110:111], v[110:111], s[50:51]
    v_cvt_pk_bf16_f32 v136, v96, v97
    v_cvt_pk_bf16_f32 v137, v98, v99
    v_cvt_pk_bf16_f32 v138, v100, v101
    v_cvt_pk_bf16_f32 v139, v102, v103
    v_cvt_pk_bf16_f32 v140, v104, v105
    v_cvt_pk_bf16_f32 v141, v106, v107
    v_cvt_pk_bf16_f32 v142, v108, v109
    v_cvt_pk_bf16_f32 v143, v110, v111
    s_nop 1
    v_mfma_f32_32x32x16_bf16 v[184:199], v[136:139], v[152:155], v[184:199]
    v_mfma_f32_32x32x16_bf16 v[200:215], v[136:139], v[20:23], v[200:215]
    v_mfma_f32_32x32x16_bf16 v[184:199], v[140:143], v[156:159], v[184:199]
    v_mfma_f32_32x32x16_bf16 v[200:215], v[140:143], v[20:23], v[200:215]
    s_nop 15
    v_cndmask_b32_e64 v184, v200, v184, s[52:53]
    v_cndmask_b32_e64 v185, v201, v185, s[52:53]
    v_cndmask_b32_e64 v186, v202, v186, s[52:53]
    v_cndmask_b32_e64 v187, v203, v187, s[52:53]
    v_cndmask_b32_e64 v188, v204, v188, s[52:53]
    v_cndmask_b32_e64 v189, v205, v189, s[52:53]
    v_cndmask_b32_e64 v190, v206, v190, s[52:53]
    v_cndmask_b32_e64 v191, v207, v191, s[52:53]
    v_cndmask_b32_e64 v192, v192, v208, s[52:53]
    v_cndmask_b32_e64 v193, v193, v209, s[52:53]
    v_cndmask_b32_e64 v194, v194, v210, s[52:53]
    v_cndmask_b32_e64 v195, v195, v211, s[52:53]
    v_cndmask_b32_e64 v196, v196, v212, s[52:53]
    v_cndmask_b32_e64 v197, v197, v213, s[52:53]
    v_cndmask_b32_e64 v198, v198, v214, s[52:53]
    v_cndmask_b32_e64 v199, v199, v215, s[52:53]
    s_lshl_b32 s24, s27, 12
    s_add_u32 s24, s24, 0
    v_add_u32 v10, s24, v9
    s_cmp_eq_u32 s26, 0
    s_cbranch_scc1 concat_heads__linear_attn_block__sliding_block__prompt_kernel_Ard
    ds_write_b128 v10, v[184:187] offset:0
    ds_write_b128 v10, v[188:191] offset:1024
    ds_write_b128 v10, v[192:195] offset:2048
    ds_write_b128 v10, v[196:199] offset:3072
    s_waitcnt lgkmcnt(0)
concat_heads__linear_attn_block__sliding_block__prompt_kernel_Ard:
    s_barrier
    s_cmp_lg_u32 s26, 0
    s_cbranch_scc1 concat_heads__linear_attn_block__sliding_block__prompt_kernel_Aq
    ds_read_b128 v[200:203], v10 offset:0
    ds_read_b128 v[204:207], v10 offset:1024
    ds_read_b128 v[208:211], v10 offset:2048
    ds_read_b128 v[212:215], v10 offset:3072
    v_and_b32 v11, 31, v1
    v_lshrrev_b32 v12, 5, v1
    v_and_b32 v13, 15, v1
    v_lshlrev_b32 v13, 5, v13
    v_lshl_add_u32 v13, v12, 9, v13
    v_lshlrev_b32 v14, 5, v12
    v_add_u32 v14, 1024, v14
    v_mov_b32 v15, 0x40000000
    v_cmp_eq_u32 s[54:55], 16, v11
    v_cmp_eq_u32 s[56:57], 0, v11
    s_nop 1
    v_cndmask_b32_e64 v16, v15, v14, s[54:55]
    v_cndmask_b32_e64 v17, v15, v14, s[56:57]
    v_cndmask_b32_e64 v16, v16, v13, s[52:53]
    v_cndmask_b32_e64 v17, v13, v17, s[52:53]
    s_lshl_b32 s24, s43, 4
    s_add_u32 s24, s24, s22
    s_mul_i32 s24, s24, 1088
    s_add_u32 s24, s24, 12582912
    s_add_u32 s25, s24, 17408
    s_waitcnt lgkmcnt(0)
    v_pk_add_f32 v[184:185], v[184:185], v[200:201]
    v_pk_add_f32 v[186:187], v[186:187], v[202:203]
    v_pk_add_f32 v[188:189], v[188:189], v[204:205]
    v_pk_add_f32 v[190:191], v[190:191], v[206:207]
    v_pk_add_f32 v[192:193], v[192:193], v[208:209]
    v_pk_add_f32 v[194:195], v[194:195], v[210:211]
    v_pk_add_f32 v[196:197], v[196:197], v[212:213]
    v_pk_add_f32 v[198:199], v[198:199], v[214:215]
    buffer_store_dwordx4 v[184:187], v16, s[16:19], s24 offen sc1
    buffer_store_dwordx4 v[188:191], v16, s[16:19], s24 offen offset:16 sc1
    buffer_store_dwordx4 v[192:195], v17, s[16:19], s25 offen sc1
    buffer_store_dwordx4 v[196:199], v17, s[16:19], s25 offen offset:16 sc1
concat_heads__linear_attn_block__sliding_block__prompt_kernel_Aq:
    v_pk_mul_f32 v[168:169], v[32:33], s[46:47]
    v_pk_mul_f32 v[170:171], v[34:35], s[46:47]
    v_pk_mul_f32 v[172:173], v[36:37], s[46:47]
    v_pk_mul_f32 v[174:175], v[38:39], s[46:47]
    v_pk_mul_f32 v[176:177], v[40:41], s[46:47]
    v_pk_mul_f32 v[178:179], v[42:43], s[46:47]
    v_pk_mul_f32 v[180:181], v[44:45], s[46:47]
    v_pk_mul_f32 v[182:183], v[46:47], s[46:47]
    v_exp_f32 v168, v168 clamp
    v_exp_f32 v169, v169 clamp
    v_exp_f32 v170, v170 clamp
    v_exp_f32 v171, v171 clamp
    v_exp_f32 v172, v172 clamp
    v_exp_f32 v173, v173 clamp
    v_exp_f32 v174, v174 clamp
    v_exp_f32 v175, v175 clamp
    v_exp_f32 v176, v176 clamp
    v_exp_f32 v177, v177 clamp
    v_exp_f32 v178, v178 clamp
    v_exp_f32 v179, v179 clamp
    v_exp_f32 v180, v180 clamp
    v_exp_f32 v181, v181 clamp
    v_exp_f32 v182, v182 clamp
    v_exp_f32 v183, v183 clamp
    v_pk_add_f32 v[32:33], v[32:33], s[48:49]
    v_pk_add_f32 v[34:35], v[34:35], s[48:49]
    v_pk_add_f32 v[36:37], v[36:37], s[48:49]
    v_pk_add_f32 v[38:39], v[38:39], s[48:49]
    v_pk_add_f32 v[40:41], v[40:41], s[48:49]
    v_pk_add_f32 v[42:43], v[42:43], s[48:49]
    v_pk_add_f32 v[44:45], v[44:45], s[48:49]
    v_pk_add_f32 v[46:47], v[46:47], s[48:49]
    v_max_f32 v32, v32, v168
    v_max_f32 v33, v33, v169
    v_max_f32 v34, v34, v170
    v_max_f32 v35, v35, v171
    v_max_f32 v36, v36, v172
    v_max_f32 v37, v37, v173
    v_max_f32 v38, v38, v174
    v_max_f32 v39, v39, v175
    v_max_f32 v40, v40, v176
    v_max_f32 v41, v41, v177
    v_max_f32 v42, v42, v178
    v_max_f32 v43, v43, v179
    v_max_f32 v44, v44, v180
    v_max_f32 v45, v45, v181
    v_max_f32 v46, v46, v182
    v_max_f32 v47, v47, v183
    v_pk_add_f32 v[32:33], v[32:33], s[50:51]
    v_pk_add_f32 v[34:35], v[34:35], s[50:51]
    v_pk_add_f32 v[36:37], v[36:37], s[50:51]
    v_pk_add_f32 v[38:39], v[38:39], s[50:51]
    v_pk_add_f32 v[40:41], v[40:41], s[50:51]
    v_pk_add_f32 v[42:43], v[42:43], s[50:51]
    v_pk_add_f32 v[44:45], v[44:45], s[50:51]
    v_pk_add_f32 v[46:47], v[46:47], s[50:51]
    v_cvt_pk_bf16_f32 v216, v32, v33
    v_cvt_pk_bf16_f32 v217, v34, v35
    v_cvt_pk_bf16_f32 v218, v36, v37
    v_cvt_pk_bf16_f32 v219, v38, v39
    v_cvt_pk_bf16_f32 v220, v40, v41
    v_cvt_pk_bf16_f32 v221, v42, v43
    v_cvt_pk_bf16_f32 v222, v44, v45
    v_cvt_pk_bf16_f32 v223, v46, v47
    s_add_u32 s24, s42, 6291456
    buffer_store_dwordx4 v[216:219], v9, s[16:19], s24 offen sc1
    s_add_u32 s25, s42, 6356992
    buffer_store_dwordx4 v[220:223], v9, s[16:19], s25 offen sc1
    v_pk_mul_f32 v[168:169], v[80:81], s[46:47]
    v_pk_mul_f32 v[170:171], v[82:83], s[46:47]
    v_pk_mul_f32 v[172:173], v[84:85], s[46:47]
    v_pk_mul_f32 v[174:175], v[86:87], s[46:47]
    v_pk_mul_f32 v[176:177], v[88:89], s[46:47]
    v_pk_mul_f32 v[178:179], v[90:91], s[46:47]
    v_pk_mul_f32 v[180:181], v[92:93], s[46:47]
    v_pk_mul_f32 v[182:183], v[94:95], s[46:47]
    v_exp_f32 v168, v168 clamp
    v_exp_f32 v169, v169 clamp
    v_exp_f32 v170, v170 clamp
    v_exp_f32 v171, v171 clamp
    v_exp_f32 v172, v172 clamp
    v_exp_f32 v173, v173 clamp
    v_exp_f32 v174, v174 clamp
    v_exp_f32 v175, v175 clamp
    v_exp_f32 v176, v176 clamp
    v_exp_f32 v177, v177 clamp
    v_exp_f32 v178, v178 clamp
    v_exp_f32 v179, v179 clamp
    v_exp_f32 v180, v180 clamp
    v_exp_f32 v181, v181 clamp
    v_exp_f32 v182, v182 clamp
    v_exp_f32 v183, v183 clamp
    v_pk_add_f32 v[80:81], v[80:81], s[48:49]
    v_pk_add_f32 v[82:83], v[82:83], s[48:49]
    v_pk_add_f32 v[84:85], v[84:85], s[48:49]
    v_pk_add_f32 v[86:87], v[86:87], s[48:49]
    v_pk_add_f32 v[88:89], v[88:89], s[48:49]
    v_pk_add_f32 v[90:91], v[90:91], s[48:49]
    v_pk_add_f32 v[92:93], v[92:93], s[48:49]
    v_pk_add_f32 v[94:95], v[94:95], s[48:49]
    v_max_f32 v80, v80, v168
    v_max_f32 v81, v81, v169
    v_max_f32 v82, v82, v170
    v_max_f32 v83, v83, v171
    v_max_f32 v84, v84, v172
    v_max_f32 v85, v85, v173
    v_max_f32 v86, v86, v174
    v_max_f32 v87, v87, v175
    v_max_f32 v88, v88, v176
    v_max_f32 v89, v89, v177
    v_max_f32 v90, v90, v178
    v_max_f32 v91, v91, v179
    v_max_f32 v92, v92, v180
    v_max_f32 v93, v93, v181
    v_max_f32 v94, v94, v182
    v_max_f32 v95, v95, v183
    v_pk_add_f32 v[80:81], v[80:81], s[50:51]
    v_pk_add_f32 v[82:83], v[82:83], s[50:51]
    v_pk_add_f32 v[84:85], v[84:85], s[50:51]
    v_pk_add_f32 v[86:87], v[86:87], s[50:51]
    v_pk_add_f32 v[88:89], v[88:89], s[50:51]
    v_pk_add_f32 v[90:91], v[90:91], s[50:51]
    v_pk_add_f32 v[92:93], v[92:93], s[50:51]
    v_pk_add_f32 v[94:95], v[94:95], s[50:51]
    v_cvt_pk_bf16_f32 v128, v80, v81
    v_cvt_pk_bf16_f32 v129, v82, v83
    v_cvt_pk_bf16_f32 v130, v84, v85
    v_cvt_pk_bf16_f32 v131, v86, v87
    v_cvt_pk_bf16_f32 v132, v88, v89
    v_cvt_pk_bf16_f32 v133, v90, v91
    v_cvt_pk_bf16_f32 v134, v92, v93
    v_cvt_pk_bf16_f32 v135, v94, v95
    s_add_u32 s24, s42, 6292480
    buffer_store_dwordx4 v[128:131], v9, s[16:19], s24 offen sc1
    s_add_u32 s25, s42, 6358016
    buffer_store_dwordx4 v[132:135], v9, s[16:19], s25 offen sc1
    s_branch concat_heads__linear_attn_block__sliding_block__prompt_kernel_p1done
concat_heads__linear_attn_block__sliding_block__prompt_kernel_cB:
    s_mov_b32 s38, 0
    s_mov_b32 s39, 0
    s_waitcnt vmcnt(0)
    v_readfirstlane_b32 s74, v31
    s_nop 3
    s_add_u32 s74, s74, 1
    s_barrier
    ds_read_b128 v[128:131], v4
    ds_read_b64_tr_b16 v[136:137], v8 offset:0
    ds_read_b64_tr_b16 v[138:139], v8 offset:512
    ds_read_b128 v[132:135], v4 offset:4096
    ds_read_b64_tr_b16 v[140:141], v8 offset:8192
    ds_read_b64_tr_b16 v[142:143], v8 offset:8704
    ds_read_b64_tr_b16 v[144:145], v8 offset:16384
    ds_read_b64_tr_b16 v[146:147], v8 offset:16896
concat_heads__linear_attn_block__sliding_block__prompt_kernel_loopB:
    s_waitcnt lgkmcnt(0)
    v_mfma_f32_32x32x16_bf16 v[32:47], v[136:139], v[128:131], v[32:47]
    ds_read_b128 v[148:151], v5
    ds_read_b64_tr_b16 v[156:157], v8 offset:2048
    ds_read_b64_tr_b16 v[158:159], v8 offset:2560
    v_mfma_f32_32x32x16_bf16 v[80:95], v[136:139], v[132:135], v[80:95]
    ds_read_b128 v[152:155], v5 offset:4096
    ds_read_b64_tr_b16 v[160:161], v8 offset:10240
    ds_read_b64_tr_b16 v[162:163], v8 offset:10752
    v_mfma_f32_32x32x16_bf16 v[48:63], v[140:143], v[128:131], v[48:63]
    ds_read_b64_tr_b16 v[164:165], v8 offset:18432
    ds_read_b64_tr_b16 v[166:167], v8 offset:18944
    v_mfma_f32_32x32x16_bf16 v[96:111], v[140:143], v[132:135], v[96:111]
    v_mfma_f32_32x32x16_bf16 v[64:79], v[128:131], v[144:147], v[64:79]
    v_mfma_f32_32x32x16_bf16 v[112:127], v[132:135], v[144:147], v[112:127]
    s_waitcnt lgkmcnt(0)
    v_mfma_f32_32x32x16_bf16 v[32:47], v[156:159], v[148:151], v[32:47]
    ds_read_b128 v[128:131], v6
    ds_read_b64_tr_b16 v[136:137], v8 offset:4096
    ds_read_b64_tr_b16 v[138:139], v8 offset:4608
    v_mfma_f32_32x32x16_bf16 v[80:95], v[156:159], v[152:155], v[80:95]
    ds_read_b128 v[132:135], v6 offset:4096
    ds_read_b64_tr_b16 v[140:141], v8 offset:12288
    ds_read_b64_tr_b16 v[142:143], v8 offset:12800
    v_mfma_f32_32x32x16_bf16 v[48:63], v[160:163], v[148:151], v[48:63]
    ds_read_b64_tr_b16 v[144:145], v8 offset:20480
    ds_read_b64_tr_b16 v[146:147], v8 offset:20992
    v_mfma_f32_32x32x16_bf16 v[96:111], v[160:163], v[152:155], v[96:111]
    v_mfma_f32_32x32x16_bf16 v[64:79], v[148:151], v[164:167], v[64:79]
    v_mfma_f32_32x32x16_bf16 v[112:127], v[152:155], v[164:167], v[112:127]
    s_waitcnt lgkmcnt(0)
    v_mfma_f32_32x32x16_bf16 v[32:47], v[136:139], v[128:131], v[32:47]
    ds_read_b128 v[148:151], v7
    ds_read_b64_tr_b16 v[156:157], v8 offset:6144
    ds_read_b64_tr_b16 v[158:159], v8 offset:6656
    v_mfma_f32_32x32x16_bf16 v[80:95], v[136:139], v[132:135], v[80:95]
    ds_read_b128 v[152:155], v7 offset:4096
    ds_read_b64_tr_b16 v[160:161], v8 offset:14336
    ds_read_b64_tr_b16 v[162:163], v8 offset:14848
    v_mfma_f32_32x32x16_bf16 v[48:63], v[140:143], v[128:131], v[48:63]
    ds_read_b64_tr_b16 v[164:165], v8 offset:22528
    ds_read_b64_tr_b16 v[166:167], v8 offset:23040
    v_mfma_f32_32x32x16_bf16 v[96:111], v[140:143], v[132:135], v[96:111]
    v_mfma_f32_32x32x16_bf16 v[64:79], v[128:131], v[144:147], v[64:79]
    v_mfma_f32_32x32x16_bf16 v[112:127], v[132:135], v[144:147], v[112:127]
    s_add_u32 s39, s39, 1
    s_cmp_eq_u32 s39, 3
    s_cselect_b32 s40, s58, s59
    s_cselect_b32 s41, s60, s61
    s_cselect_b32 s39, 0, s39
    s_waitcnt lgkmcnt(0)
    s_barrier
    v_add_u32 v4, s40, v4
    v_add_u32 v5, s40, v5
    v_add_u32 v6, s40, v6
    v_add_u32 v7, s40, v7
    v_add_u32 v8, s41, v8
    v_mfma_f32_32x32x16_bf16 v[32:47], v[156:159], v[148:151], v[32:47]
    ds_read_b128 v[128:131], v4
    ds_read_b64_tr_b16 v[136:137], v8 offset:0
    ds_read_b64_tr_b16 v[138:139], v8 offset:512
    v_mfma_f32_32x32x16_bf16 v[80:95], v[156:159], v[152:155], v[80:95]
    ds_read_b128 v[132:135], v4 offset:4096
    ds_read_b64_tr_b16 v[140:141], v8 offset:8192
    ds_read_b64_tr_b16 v[142:143], v8 offset:8704
    v_mfma_f32_32x32x16_bf16 v[48:63], v[160:163], v[148:151], v[48:63]
    ds_read_b64_tr_b16 v[144:145], v8 offset:16384
    ds_read_b64_tr_b16 v[146:147], v8 offset:16896
    v_mfma_f32_32x32x16_bf16 v[96:111], v[160:163], v[152:155], v[96:111]
    v_mfma_f32_32x32x16_bf16 v[64:79], v[148:151], v[164:167], v[64:79]
    v_mfma_f32_32x32x16_bf16 v[112:127], v[152:155], v[164:167], v[112:127]
    s_add_u32 s38, s38, 1
    s_cmp_lt_u32 s38, 7
    s_cbranch_scc1 concat_heads__linear_attn_block__sliding_block__prompt_kernel_loopB
    s_waitcnt lgkmcnt(0)
    v_mfma_f32_32x32x16_bf16 v[32:47], v[136:139], v[128:131], v[32:47]
    ds_read_b128 v[148:151], v5
    ds_read_b64_tr_b16 v[156:157], v8 offset:2048
    ds_read_b64_tr_b16 v[158:159], v8 offset:2560
    v_mfma_f32_32x32x16_bf16 v[80:95], v[136:139], v[132:135], v[80:95]
    ds_read_b128 v[152:155], v5 offset:4096
    ds_read_b64_tr_b16 v[160:161], v8 offset:10240
    ds_read_b64_tr_b16 v[162:163], v8 offset:10752
    v_mfma_f32_32x32x16_bf16 v[48:63], v[140:143], v[128:131], v[48:63]
    ds_read_b64_tr_b16 v[164:165], v8 offset:18432
    ds_read_b64_tr_b16 v[166:167], v8 offset:18944
    v_mfma_f32_32x32x16_bf16 v[96:111], v[140:143], v[132:135], v[96:111]
    v_mfma_f32_32x32x16_bf16 v[64:79], v[128:131], v[144:147], v[64:79]
    v_mfma_f32_32x32x16_bf16 v[112:127], v[132:135], v[144:147], v[112:127]
    s_waitcnt lgkmcnt(0)
    v_mfma_f32_32x32x16_bf16 v[32:47], v[156:159], v[148:151], v[32:47]
    ds_read_b128 v[128:131], v6
    ds_read_b64_tr_b16 v[136:137], v8 offset:4096
    ds_read_b64_tr_b16 v[138:139], v8 offset:4608
    v_mfma_f32_32x32x16_bf16 v[80:95], v[156:159], v[152:155], v[80:95]
    ds_read_b128 v[132:135], v6 offset:4096
    ds_read_b64_tr_b16 v[140:141], v8 offset:12288
    ds_read_b64_tr_b16 v[142:143], v8 offset:12800
    v_mfma_f32_32x32x16_bf16 v[48:63], v[160:163], v[148:151], v[48:63]
    ds_read_b64_tr_b16 v[144:145], v8 offset:20480
    ds_read_b64_tr_b16 v[146:147], v8 offset:20992
    v_mfma_f32_32x32x16_bf16 v[96:111], v[160:163], v[152:155], v[96:111]
    v_mfma_f32_32x32x16_bf16 v[64:79], v[148:151], v[164:167], v[64:79]
    v_mfma_f32_32x32x16_bf16 v[112:127], v[152:155], v[164:167], v[112:127]
    s_waitcnt lgkmcnt(0)
    v_mfma_f32_32x32x16_bf16 v[32:47], v[136:139], v[128:131], v[32:47]
    ds_read_b128 v[148:151], v7
    ds_read_b64_tr_b16 v[156:157], v8 offset:6144
    ds_read_b64_tr_b16 v[158:159], v8 offset:6656
    v_mfma_f32_32x32x16_bf16 v[80:95], v[136:139], v[132:135], v[80:95]
    ds_read_b128 v[152:155], v7 offset:4096
    ds_read_b64_tr_b16 v[160:161], v8 offset:14336
    ds_read_b64_tr_b16 v[162:163], v8 offset:14848
    v_mfma_f32_32x32x16_bf16 v[48:63], v[140:143], v[128:131], v[48:63]
    ds_read_b64_tr_b16 v[164:165], v8 offset:22528
    ds_read_b64_tr_b16 v[166:167], v8 offset:23040
    v_mfma_f32_32x32x16_bf16 v[96:111], v[140:143], v[132:135], v[96:111]
    v_mfma_f32_32x32x16_bf16 v[64:79], v[128:131], v[144:147], v[64:79]
    v_mfma_f32_32x32x16_bf16 v[112:127], v[132:135], v[144:147], v[112:127]
    s_waitcnt lgkmcnt(0)
    v_mfma_f32_32x32x16_bf16 v[32:47], v[156:159], v[148:151], v[32:47]
    v_mfma_f32_32x32x16_bf16 v[80:95], v[156:159], v[152:155], v[80:95]
    v_mfma_f32_32x32x16_bf16 v[48:63], v[160:163], v[148:151], v[48:63]
    v_mfma_f32_32x32x16_bf16 v[96:111], v[160:163], v[152:155], v[96:111]
    v_mfma_f32_32x32x16_bf16 v[64:79], v[148:151], v[164:167], v[64:79]
    v_mfma_f32_32x32x16_bf16 v[112:127], v[152:155], v[164:167], v[112:127]
    s_lshl_b32 s43, s23, 2
    s_lshl_b32 s24, s27, 1
    s_add_u32 s43, s43, s24
    s_lshl_b32 s44, s22, 2
    s_lshl_b32 s24, s26, 1
    s_add_u32 s44, s44, s24
    s_lshl_b32 s42, s43, 16
    s_lshl_b32 s24, s44, 10
    s_add_u32 s42, s42, s24
    v_lshlrev_b32 v9, 4, v1
    s_mov_b32 s46, 0x3eb8aa3b
    s_mov_b32 s47, 0x3eb8aa3b
    v_bfe_u32 v10, v1, 4, 1
    v_lshlrev_b32 v10, 16, v10
    v_lshrrev_b32 v11, 5, v1
    v_lshl_add_u32 v10, v11, 8, v10
    v_and_b32 v11, 15, v1
    v_lshl_add_u32 v10, v11, 4, v10
    s_nop 7
    v_cvt_pk_bf16_f32 v128, v48, v49
    v_cvt_pk_bf16_f32 v129, v50, v51
    v_cvt_pk_bf16_f32 v130, v52, v53
    v_cvt_pk_bf16_f32 v131, v54, v55
    v_cvt_pk_bf16_f32 v132, v56, v57
    v_cvt_pk_bf16_f32 v133, v58, v59
    v_cvt_pk_bf16_f32 v134, v60, v61
    v_cvt_pk_bf16_f32 v135, v62, v63
    s_add_u32 s24, s42, 2097152
    buffer_store_dwordx4 v[128:131], v9, s[16:19], s24 offen sc1
    s_add_u32 s25, s42, 2162688
    buffer_store_dwordx4 v[132:135], v9, s[16:19], s25 offen sc1
    v_cvt_pk_bf16_f32 v136, v96, v97
    v_cvt_pk_bf16_f32 v137, v98, v99
    v_cvt_pk_bf16_f32 v138, v100, v101
    v_cvt_pk_bf16_f32 v139, v102, v103
    v_cvt_pk_bf16_f32 v140, v104, v105
    v_cvt_pk_bf16_f32 v141, v106, v107
    v_cvt_pk_bf16_f32 v142, v108, v109
    v_cvt_pk_bf16_f32 v143, v110, v111
    s_add_u32 s24, s42, 2098176
    buffer_store_dwordx4 v[136:139], v9, s[16:19], s24 offen sc1
    s_add_u32 s25, s42, 2163712
    buffer_store_dwordx4 v[140:143], v9, s[16:19], s25 offen sc1
    v_cvt_pk_bf16_f32 v144, v64, v65
    v_cvt_pk_bf16_f32 v145, v66, v67
    v_cvt_pk_bf16_f32 v146, v68, v69
    v_cvt_pk_bf16_f32 v147, v70, v71
    v_cvt_pk_bf16_f32 v148, v72, v73
    v_cvt_pk_bf16_f32 v149, v74, v75
    v_cvt_pk_bf16_f32 v150, v76, v77
    v_cvt_pk_bf16_f32 v151, v78, v79
    s_add_u32 s24, s42, 4194304
    buffer_store_dwordx4 v[144:147], v10, s[16:19], s24 offen sc1
    buffer_store_dwordx4 v[148:151], v10, s[16:19], s24 offen offset:512 sc1
    v_cvt_pk_bf16_f32 v152, v112, v113
    v_cvt_pk_bf16_f32 v153, v114, v115
    v_cvt_pk_bf16_f32 v154, v116, v117
    v_cvt_pk_bf16_f32 v155, v118, v119
    v_cvt_pk_bf16_f32 v156, v120, v121
    v_cvt_pk_bf16_f32 v157, v122, v123
    v_cvt_pk_bf16_f32 v158, v124, v125
    v_cvt_pk_bf16_f32 v159, v126, v127
    s_add_u32 s24, s42, 4195328
    buffer_store_dwordx4 v[152:155], v10, s[16:19], s24 offen sc1
    buffer_store_dwordx4 v[156:159], v10, s[16:19], s24 offen offset:512 sc1
    v_pk_mul_f32 v[32:33], v[32:33], s[46:47]
    v_pk_mul_f32 v[34:35], v[34:35], s[46:47]
    v_pk_mul_f32 v[36:37], v[36:37], s[46:47]
    v_pk_mul_f32 v[38:39], v[38:39], s[46:47]
    v_pk_mul_f32 v[40:41], v[40:41], s[46:47]
    v_pk_mul_f32 v[42:43], v[42:43], s[46:47]
    v_pk_mul_f32 v[44:45], v[44:45], s[46:47]
    v_pk_mul_f32 v[46:47], v[46:47], s[46:47]
    v_cvt_pk_bf16_f32 v160, v32, v33
    v_cvt_pk_bf16_f32 v161, v34, v35
    v_cvt_pk_bf16_f32 v162, v36, v37
    v_cvt_pk_bf16_f32 v163, v38, v39
    v_cvt_pk_bf16_f32 v164, v40, v41
    v_cvt_pk_bf16_f32 v165, v42, v43
    v_cvt_pk_bf16_f32 v166, v44, v45
    v_cvt_pk_bf16_f32 v167, v46, v47
    s_add_u32 s24, s42, 0
    buffer_store_dwordx4 v[160:163], v9, s[16:19], s24 offen sc1
    s_add_u32 s25, s42, 65536
    buffer_store_dwordx4 v[164:167], v9, s[16:19], s25 offen sc1
    v_pk_mul_f32 v[80:81], v[80:81], s[46:47]
    v_pk_mul_f32 v[82:83], v[82:83], s[46:47]
    v_pk_mul_f32 v[84:85], v[84:85], s[46:47]
    v_pk_mul_f32 v[86:87], v[86:87], s[46:47]
    v_pk_mul_f32 v[88:89], v[88:89], s[46:47]
    v_pk_mul_f32 v[90:91], v[90:91], s[46:47]
    v_pk_mul_f32 v[92:93], v[92:93], s[46:47]
    v_pk_mul_f32 v[94:95], v[94:95], s[46:47]
    v_cvt_pk_bf16_f32 v168, v80, v81
    v_cvt_pk_bf16_f32 v169, v82, v83
    v_cvt_pk_bf16_f32 v170, v84, v85
    v_cvt_pk_bf16_f32 v171, v86, v87
    v_cvt_pk_bf16_f32 v172, v88, v89
    v_cvt_pk_bf16_f32 v173, v90, v91
    v_cvt_pk_bf16_f32 v174, v92, v93
    v_cvt_pk_bf16_f32 v175, v94, v95
    s_add_u32 s24, s42, 1024
    buffer_store_dwordx4 v[168:171], v9, s[16:19], s24 offen sc1
    s_add_u32 s25, s42, 66560
    buffer_store_dwordx4 v[172:175], v9, s[16:19], s25 offen sc1
    s_branch concat_heads__linear_attn_block__sliding_block__prompt_kernel_p1done
concat_heads__linear_attn_block__sliding_block__prompt_kernel_p1done:
    s_waitcnt vmcnt(0)
concat_heads__linear_attn_block__sliding_block__prompt_kernel_p1bar:
    s_barrier
    s_cmp_lg_u32 s75, 0
    s_cbranch_scc1 concat_heads__linear_attn_block__sliding_block__prompt_kernel_nf1
    s_lshl_b32 s24, s21, 3
    s_add_u32 s24, s24, s23
    s_mul_i32 s24, s24, 2304
    s_lshl_b32 s25, s22, 7
    s_add_u32 s24, s24, s25
    s_add_u32 s24, s24, 13172736
    v_mov_b32 v12, 0
    v_mov_b32 v13, s74
    buffer_store_dword v13, v12, s[16:19], s24 offen sc1
concat_heads__linear_attn_block__sliding_block__prompt_kernel_nf1:
    s_mov_b32 s20, s75
    s_bfe_u32 s21, s2, 0x30003
    s_and_b32 s22, s2, 7
    s_lshr_b32 s24, s2, 6
    s_lshl_b32 s24, s24, 3
    s_add_u32 s22, s22, s24
    v_lshlrev_b32 v3, 4, v1
    s_lshl_b32 s23, s21, 3
    s_add_u32 s23, s23, s20
    s_mov_b32 s8, s72
    s_mov_b32 s9, s73
    s_mov_b32 s10, 13631488
    s_mov_b32 s11, 0x20000
    v_mov_b32 v12, 0x3f803f80
    v_mov_b32 v13, 0x3f803f80
    v_mov_b32 v14, 0x3f803f80
    v_mov_b32 v15, 0x3f803f80
    s_lshl_b32 s24, s20, 10
    s_add_u32 s24, s24, 32768
    v_add_u32 v16, s24, v3
    ds_write_b128 v16, v[12:15]
    v_add_u32 v16, 40960, v3
    ds_write_b128 v16, v[12:15]
    s_mov_b32 s32, 0xffffffff
    s_mov_b32 s33, 0xfffffff0
    s_mov_b32 s34, 0xfffffffe
    s_mov_b32 s35, 0xffffffe0
    s_mov_b32 s36, 0xfffffffc
    s_mov_b32 s37, 0xffffffc0
    s_mov_b32 s38, 0xfffffff8
    s_mov_b32 s39, 0xffffff80
    s_mov_b32 s40, 0xffffff00
    s_mov_b32 s41, 0xfffff000
    s_mov_b32 s42, 0xfffffe00
    s_mov_b32 s43, 0xffffe000
    s_mov_b32 s44, 0xfffffc00
    s_mov_b32 s45, 0xffffc000
    s_mov_b32 s46, 0xfffff800
    s_mov_b32 s47, 0xffff8000
    s_mov_b32 s48, 0xffff0000
    s_mov_b32 s49, 0xfff00000
    s_mov_b32 s50, 0xfffe0000
    s_mov_b32 s51, 0xffe00000
    s_mov_b32 s52, 0xfffc0000
    s_mov_b32 s53, 0xffc00000
    s_mov_b32 s54, 0xfff80000
    s_mov_b32 s55, 0xff800000
    s_mov_b32 s56, 0xff000000
    s_mov_b32 s57, 0xf0000000
    s_mov_b32 s58, 0xfe000000
    s_mov_b32 s59, 0xe0000000
    s_mov_b32 s60, 0xfc000000
    s_mov_b32 s61, 0xc0000000
    s_mov_b32 s62, 0xf8000000
    s_mov_b32 s63, 0x80000000
    v_mov_b32 v24, 0xffff
    v_mov_b32 v25, 0xffff0000
    v_cndmask_b32_e64 v16, 0, v24, s[32:33]
    v_cndmask_b32_e64 v26, 0, v25, s[34:35]
    v_or_b32 v16, v16, v26
    v_cndmask_b32_e64 v17, 0, v24, s[36:37]
    v_cndmask_b32_e64 v26, 0, v25, s[38:39]
    v_or_b32 v17, v17, v26
    v_cndmask_b32_e64 v18, 0, v24, s[40:41]
    v_cndmask_b32_e64 v26, 0, v25, s[42:43]
    v_or_b32 v18, v18, v26
    v_cndmask_b32_e64 v19, 0, v24, s[44:45]
    v_cndmask_b32_e64 v26, 0, v25, s[46:47]
    v_or_b32 v19, v19, v26
    v_cndmask_b32_e64 v20, 0, v24, s[48:49]
    v_cndmask_b32_e64 v26, 0, v25, s[50:51]
    v_or_b32 v20, v20, v26
    v_cndmask_b32_e64 v21, 0, v24, s[52:53]
    v_cndmask_b32_e64 v26, 0, v25, s[54:55]
    v_or_b32 v21, v21, v26
    v_cndmask_b32_e64 v22, 0, v24, s[56:57]
    v_cndmask_b32_e64 v26, 0, v25, s[58:59]
    v_or_b32 v22, v22, v26
    v_cndmask_b32_e64 v23, 0, v24, s[60:61]
    v_cndmask_b32_e64 v26, 0, v25, s[62:63]
    v_or_b32 v23, v23, v26
    s_lshl_b32 s24, s20, 10
    s_add_u32 s25, s24, 0
    v_add_u32 v24, s25, v3
    v_and_b32 v28, 31, v1
    v_lshrrev_b32 v29, 5, v1
    v_lshlrev_b32 v30, 4, v28
    v_lshl_add_u32 v30, v29, 8, v30
    s_add_u32 s25, s24, 16384
    v_add_u32 v30, s25, v30
    v_subrev_u32 v31, 20, v28
    v_cmp_gt_u32 vcc, 8, v31
    v_mov_b32 v31, 32768
    v_mov_b32 v12, 32832
    v_cndmask_b32_e64 v31, v31, v12, vcc
    v_cmp_gt_u32 vcc, 16, v28
    s_nop 1
    v_cndmask_b32_e64 v25, v31, v30, vcc
    v_lshlrev_b32 v30, 5, v28
    v_lshl_add_u32 v30, v29, 9, v30
    v_lshlrev_b32 v31, 5, v29
    v_add_u32 v31, 1024, v31
    v_cndmask_b32_e64 v26, v31, v30, vcc
    v_add_u32 v26, 59392, v26
    s_sub_u32 s26, 8, s20
    s_cmp_eq_u32 s21, 0
    s_cselect_b32 s26, s26, 1
    v_lshlrev_b32 v2, 7, v1
    s_lshr_b32 s12, s22, 2
    s_mul_i32 s12, s12, 2304
    s_add_u32 s13, s12, 13172736
    s_add_u32 s12, s12, 13191168
    s_cmp_lg_u32 s75, 0
    s_cbranch_scc1 concat_heads__linear_attn_block__sliding_block__prompt_kernel_np2
    s_lshl_b32 s24, s21, 1
    s_lshl_b32 s14, 15, s24
    s_lshr_b32 s14, s14, 2
    s_mov_b32 s15, 0
    s_mov_b32 s79, 0
    s_mov_b64 exec, s[14:15]
pb_2:
    buffer_load_dword v12, v2, s[8:11], s12 offen sc1
    s_waitcnt vmcnt(0)
    v_cmp_eq_u32 vcc, s74, v12
    s_cmp_eq_u64 vcc, s[14:15]
    s_cbranch_scc1 pbd_3
    s_add_u32 s79, s79, 1
    s_cmp_lt_u32 s79, 30000
    s_cbranch_scc0 pbd_3
    s_sleep 1
    s_branch pb_2
pbd_3:
    s_mov_b64 exec, -1
concat_heads__linear_attn_block__sliding_block__prompt_kernel_np2:
    s_waitcnt lgkmcnt(0)
    s_barrier
    s_lshl_b32 s27, s22, 16
    s_lshl_b32 s24, s23, 10
    s_add_u32 s24, s24, s27
    s_add_u32 s25, s24, 0
    buffer_load_dwordx4 v[4:7], v3, s[8:11], s25 offen sc1
    s_lshl_b32 s24, s20, 1
    s_add_u32 s24, s24, 0
    s_lshl_b32 s25, s21, 3
    s_add_u32 s25, s25, s24
    s_sub_i32 s25, s25, 8
    s_max_i32 s25, s25, 0
    s_lshl_b32 s25, s25, 10
    s_add_u32 s25, s25, s27
    s_lshl_b32 s24, s24, 10
    s_add_u32 m0, s24, 0
    s_add_u32 s28, s25, 2097152
    buffer_load_dwordx4 v3, s[8:11], s28 offen sc1 lds
    s_add_u32 m0, s24, 16384
    s_add_u32 s28, s25, 4194304
    buffer_load_dwordx4 v3, s[8:11], s28 offen sc1 lds
    s_lshl_b32 s24, s20, 1
    s_add_u32 s24, s24, 1
    s_lshl_b32 s25, s21, 3
    s_add_u32 s25, s25, s24
    s_sub_i32 s25, s25, 8
    s_max_i32 s25, s25, 0
    s_lshl_b32 s25, s25, 10
    s_add_u32 s25, s25, s27
    s_lshl_b32 s24, s24, 10
    s_add_u32 m0, s24, 0
    s_add_u32 s28, s25, 2097152
    buffer_load_dwordx4 v3, s[8:11], s28 offen sc1 lds
    s_add_u32 m0, s24, 16384
    s_add_u32 s28, s25, 4194304
    buffer_load_dwordx4 v3, s[8:11], s28 offen sc1 lds
    s_waitcnt vmcnt(0) lgkmcnt(0)
    s_barrier
    ds_read_b128 v[32:35], v24 offset:0
    ds_read_b128 v[36:39], v24 offset:8192
    ds_read_b128 v[40:43], v24 offset:7168
    ds_read_b128 v[196:199], v25 offset:8192
    ds_read_b128 v[200:203], v25 offset:8704
    ds_read_b128 v[204:207], v25 offset:0
    ds_read_b128 v[208:211], v25 offset:512
    s_cmp_eq_u32 s21, 0
    s_cbranch_scc1 concat_heads__linear_attn_block__sliding_block__prompt_kernel_f0a
    s_waitcnt lgkmcnt(6)
    v_mfma_f32_32x32x16_bf16 v[68:83], v[32:35], v[4:7], 0
    s_branch concat_heads__linear_attn_block__sliding_block__prompt_kernel_f0b
concat_heads__linear_attn_block__sliding_block__prompt_kernel_f0a:
    v_mov_b32 v68, 0xf149f2ca
    v_mov_b32 v69, 0xf149f2ca
    v_mov_b32 v70, 0xf149f2ca
    v_mov_b32 v71, 0xf149f2ca
    v_mov_b32 v72, 0xf149f2ca
    v_mov_b32 v73, 0xf149f2ca
    v_mov_b32 v74, 0xf149f2ca
    v_mov_b32 v75, 0xf149f2ca
    v_mov_b32 v76, 0xf149f2ca
    v_mov_b32 v77, 0xf149f2ca
    v_mov_b32 v78, 0xf149f2ca
    v_mov_b32 v79, 0xf149f2ca
    v_mov_b32 v80, 0xf149f2ca
    v_mov_b32 v81, 0xf149f2ca
    v_mov_b32 v82, 0xf149f2ca
    v_mov_b32 v83, 0xf149f2ca
concat_heads__linear_attn_block__sliding_block__prompt_kernel_f0b:
    s_waitcnt lgkmcnt(5)
    v_mfma_f32_32x32x16_bf16 v[84:99], v[36:39], v[4:7], 0
    s_waitcnt lgkmcnt(4)
    v_mfma_f32_32x32x16_bf16 v[100:115], v[40:43], v[4:7], 0
    ds_read_b128 v[32:35], v24 offset:6144
    s_mov_b64 exec, 0xffff
    buffer_load_dword v13, v2, s[8:11], s13 offen sc1
    s_mov_b64 exec, -1
    s_nop 7
    s_nop 1
    v_cndmask_b32_e64 v132, v68, v84, s[32:33]
    v_cndmask_b32_e64 v133, v69, v85, s[34:35]
    v_cndmask_b32_e64 v134, v70, v86, s[36:37]
    v_cndmask_b32_e64 v135, v71, v87, s[38:39]
    v_cndmask_b32_e64 v136, v72, v88, s[40:41]
    v_cndmask_b32_e64 v137, v73, v89, s[42:43]
    v_cndmask_b32_e64 v138, v74, v90, s[44:45]
    v_cndmask_b32_e64 v139, v75, v91, s[46:47]
    v_cndmask_b32_e64 v140, v76, v92, s[48:49]
    v_cndmask_b32_e64 v141, v77, v93, s[50:51]
    v_cndmask_b32_e64 v142, v78, v94, s[52:53]
    v_cndmask_b32_e64 v143, v79, v95, s[54:55]
    v_cndmask_b32_e64 v144, v80, v96, s[56:57]
    v_cndmask_b32_e64 v145, v81, v97, s[58:59]
    v_cndmask_b32_e64 v146, v82, v98, s[60:61]
    v_cndmask_b32_e64 v147, v83, v99, s[62:63]
    v_exp_f32 v132, v132
    v_exp_f32 v133, v133
    v_exp_f32 v134, v134
    v_exp_f32 v135, v135
    v_exp_f32 v136, v136
    v_exp_f32 v137, v137
    v_exp_f32 v138, v138
    v_exp_f32 v139, v139
    v_exp_f32 v140, v140
    v_exp_f32 v141, v141
    v_exp_f32 v142, v142
    v_exp_f32 v143, v143
    v_exp_f32 v144, v144
    v_exp_f32 v145, v145
    v_exp_f32 v146, v146
    v_exp_f32 v147, v147
    s_nop 0
    v_cvt_pk_bf16_f32 v180, v132, v133
    v_cvt_pk_bf16_f32 v181, v134, v135
    v_cvt_pk_bf16_f32 v182, v136, v137
    v_cvt_pk_bf16_f32 v183, v138, v139
    v_cvt_pk_bf16_f32 v184, v140, v141
    v_cvt_pk_bf16_f32 v185, v142, v143
    v_cvt_pk_bf16_f32 v186, v144, v145
    v_cvt_pk_bf16_f32 v187, v146, v147
    v_and_b32 v188, v180, v16
    v_and_b32 v189, v181, v17
    v_and_b32 v190, v182, v18
    v_and_b32 v191, v183, v19
    v_and_b32 v192, v184, v20
    v_and_b32 v193, v185, v21
    v_and_b32 v194, v186, v22
    v_and_b32 v195, v187, v23
    v_xor_b32 v180, v180, v188
    v_xor_b32 v181, v181, v189
    v_xor_b32 v182, v182, v190
    v_xor_b32 v183, v183, v191
    v_xor_b32 v184, v184, v192
    v_xor_b32 v185, v185, v193
    v_xor_b32 v186, v186, v194
    v_xor_b32 v187, v187, v195
    s_waitcnt lgkmcnt(1)
    v_mfma_f32_32x32x16_bf16 v[164:179], v[196:199], v[188:191], 0
    v_mfma_f32_32x32x16_bf16 v[164:179], v[200:203], v[192:195], v[164:179]
    s_cmp_eq_u32 s21, 0
    s_cbranch_scc1 concat_heads__linear_attn_block__sliding_block__prompt_kernel_fskip0
    v_mfma_f32_32x32x16_bf16 v[164:179], v[204:207], v[180:183], v[164:179]
    v_mfma_f32_32x32x16_bf16 v[164:179], v[208:211], v[184:187], v[164:179]
concat_heads__linear_attn_block__sliding_block__prompt_kernel_fskip0:
    s_mov_b32 s14, 0xffff
    s_mov_b32 s15, 0
    s_waitcnt vmcnt(0)
    v_cmp_eq_u32 vcc, s74, v13
    s_and_b64 vcc, vcc, s[14:15]
    s_cmp_eq_u64 vcc, s[14:15]
    s_cbranch_scc1 pa_4
    s_mov_b32 s79, 0
    s_mov_b64 exec, s[14:15]
pa2_5:
    buffer_load_dword v13, v2, s[8:11], s13 offen sc1
    s_waitcnt vmcnt(0)
    v_cmp_eq_u32 vcc, s74, v13
    s_cmp_eq_u64 vcc, s[14:15]
    s_cbranch_scc1 pa2d_6
    s_add_u32 s79, s79, 1
    s_cmp_lt_u32 s79, 30000
    s_cbranch_scc0 pa2d_6
    s_sleep 4
    s_branch pa2_5
pa2d_6:
    s_mov_b64 exec, -1
pa_4:
    s_mul_i32 s28, s22, 17408
    s_add_u32 s28, s28, 12582912
    s_cmp_lg_u32 s20, 0
    s_cbranch_scc1 concat_heads__linear_attn_block__sliding_block__prompt_kernel_nokv16
    s_mov_b32 m0, 58368
    s_add_u32 s24, s28, 16384
    buffer_load_dwordx4 v3, s[8:11], s24 offen sc1 lds
concat_heads__linear_attn_block__sliding_block__prompt_kernel_nokv16:
    s_lshl_b32 s25, s20, 10
    s_add_u32 m0, s25, 41984
    s_add_u32 s24, s28, s25
    buffer_load_dwordx4 v3, s[8:11], s24 offen sc1 lds
    s_add_u32 m0, s25, 50176
    s_add_u32 s24, s24, 8192
    buffer_load_dwordx4 v3, s[8:11], s24 offen sc1 lds
    s_lshl_b32 s24, s22, 16
    s_lshl_b32 s25, s23, 10
    s_add_u32 s24, s24, s25
    s_add_u32 s24, s24, 6291456
    buffer_load_dwordx4 v[8:11], v3, s[8:11], s24 offen sc1
    s_cmp_gt_u32 s26, 7
    s_cbranch_scc1 concat_heads__linear_attn_block__sliding_block__prompt_kernel_fend
    s_waitcnt lgkmcnt(0)
    v_mfma_f32_32x32x16_bf16 v[116:131], v[32:35], v[4:7], 0
    ds_read_b128 v[36:39], v24 offset:5120
    v_exp_f32 v100, v100
    v_exp_f32 v101, v101
    v_exp_f32 v102, v102
    v_exp_f32 v103, v103
    v_exp_f32 v104, v104
    v_exp_f32 v105, v105
    v_exp_f32 v106, v106
    v_exp_f32 v107, v107
    ds_read_b128 v[196:199], v25 offset:7168
    ds_read_b128 v[200:203], v25 offset:7680
    v_exp_f32 v108, v108
    v_exp_f32 v109, v109
    v_exp_f32 v110, v110
    v_exp_f32 v111, v111
    v_exp_f32 v112, v112
    v_exp_f32 v113, v113
    v_exp_f32 v114, v114
    v_exp_f32 v115, v115
    s_nop 0
    v_cvt_pk_bf16_f32 v188, v100, v101
    v_cvt_pk_bf16_f32 v189, v102, v103
    v_cvt_pk_bf16_f32 v190, v104, v105
    v_cvt_pk_bf16_f32 v191, v106, v107
    v_cvt_pk_bf16_f32 v192, v108, v109
    v_cvt_pk_bf16_f32 v193, v110, v111
    v_cvt_pk_bf16_f32 v194, v112, v113
    v_cvt_pk_bf16_f32 v195, v114, v115
    s_cmp_gt_u32 s26, 6
    s_cbranch_scc1 concat_heads__linear_attn_block__sliding_block__prompt_kernel_fendp1
    s_waitcnt lgkmcnt(2)
    v_mfma_f32_32x32x16_bf16 v[100:115], v[36:39], v[4:7], 0
    ds_read_b128 v[32:35], v24 offset:4096
    v_exp_f32 v116, v116
    v_exp_f32 v117, v117
    v_exp_f32 v118, v118
    v_exp_f32 v119, v119
    s_waitcnt lgkmcnt(1)
    v_mfma_f32_32x32x16_bf16 v[164:179], v[196:199], v[188:191], v[164:179]
    v_exp_f32 v120, v120
    v_exp_f32 v121, v121
    v_exp_f32 v122, v122
    v_exp_f32 v123, v123
    v_mfma_f32_32x32x16_bf16 v[164:179], v[200:203], v[192:195], v[164:179]
    ds_read_b128 v[204:207], v25 offset:6144
    ds_read_b128 v[208:211], v25 offset:6656
    v_exp_f32 v124, v124
    v_exp_f32 v125, v125
    v_exp_f32 v126, v126
    v_exp_f32 v127, v127
    v_exp_f32 v128, v128
    v_exp_f32 v129, v129
    v_exp_f32 v130, v130
    v_exp_f32 v131, v131
    s_nop 0
    v_cvt_pk_bf16_f32 v180, v116, v117
    v_cvt_pk_bf16_f32 v181, v118, v119
    v_cvt_pk_bf16_f32 v182, v120, v121
    v_cvt_pk_bf16_f32 v183, v122, v123
    v_cvt_pk_bf16_f32 v184, v124, v125
    v_cvt_pk_bf16_f32 v185, v126, v127
    v_cvt_pk_bf16_f32 v186, v128, v129
    v_cvt_pk_bf16_f32 v187, v130, v131
    s_cmp_gt_u32 s26, 5
    s_cbranch_scc1 concat_heads__linear_attn_block__sliding_block__prompt_kernel_fendp2
    s_waitcnt lgkmcnt(2)
    v_mfma_f32_32x32x16_bf16 v[116:131], v[32:35], v[4:7], 0
    ds_read_b128 v[36:39], v24 offset:3072
    v_exp_f32 v100, v100
    v_exp_f32 v101, v101
    v_exp_f32 v102, v102
    v_exp_f32 v103, v103
    s_waitcnt lgkmcnt(1)
    v_mfma_f32_32x32x16_bf16 v[164:179], v[204:207], v[180:183], v[164:179]
    v_exp_f32 v104, v104
    v_exp_f32 v105, v105
    v_exp_f32 v106, v106
    v_exp_f32 v107, v107
    v_mfma_f32_32x32x16_bf16 v[164:179], v[208:211], v[184:187], v[164:179]
    ds_read_b128 v[196:199], v25 offset:5120
    ds_read_b128 v[200:203], v25 offset:5632
    v_exp_f32 v108, v108
    v_exp_f32 v109, v109
    v_exp_f32 v110, v110
    v_exp_f32 v111, v111
    v_exp_f32 v112, v112
    v_exp_f32 v113, v113
    v_exp_f32 v114, v114
    v_exp_f32 v115, v115
    s_nop 0
    v_cvt_pk_bf16_f32 v188, v100, v101
    v_cvt_pk_bf16_f32 v189, v102, v103
    v_cvt_pk_bf16_f32 v190, v104, v105
    v_cvt_pk_bf16_f32 v191, v106, v107
    v_cvt_pk_bf16_f32 v192, v108, v109
    v_cvt_pk_bf16_f32 v193, v110, v111
    v_cvt_pk_bf16_f32 v194, v112, v113
    v_cvt_pk_bf16_f32 v195, v114, v115
    s_cmp_gt_u32 s26, 4
    s_cbranch_scc1 concat_heads__linear_attn_block__sliding_block__prompt_kernel_fendp3
    s_waitcnt lgkmcnt(2)
    v_mfma_f32_32x32x16_bf16 v[100:115], v[36:39], v[4:7], 0
    ds_read_b128 v[32:35], v24 offset:2048
    v_exp_f32 v116, v116
    v_exp_f32 v117, v117
    v_exp_f32 v118, v118
    v_exp_f32 v119, v119
    s_waitcnt lgkmcnt(1)
    v_mfma_f32_32x32x16_bf16 v[164:179], v[196:199], v[188:191], v[164:179]
    v_exp_f32 v120, v120
    v_exp_f32 v121, v121
    v_exp_f32 v122, v122
    v_exp_f32 v123, v123
    v_mfma_f32_32x32x16_bf16 v[164:179], v[200:203], v[192:195], v[164:179]
    ds_read_b128 v[204:207], v25 offset:4096
    ds_read_b128 v[208:211], v25 offset:4608
    v_exp_f32 v124, v124
    v_exp_f32 v125, v125
    v_exp_f32 v126, v126
    v_exp_f32 v127, v127
    v_exp_f32 v128, v128
    v_exp_f32 v129, v129
    v_exp_f32 v130, v130
    v_exp_f32 v131, v131
    s_nop 0
    v_cvt_pk_bf16_f32 v180, v116, v117
    v_cvt_pk_bf16_f32 v181, v118, v119
    v_cvt_pk_bf16_f32 v182, v120, v121
    v_cvt_pk_bf16_f32 v183, v122, v123
    v_cvt_pk_bf16_f32 v184, v124, v125
    v_cvt_pk_bf16_f32 v185, v126, v127
    v_cvt_pk_bf16_f32 v186, v128, v129
    v_cvt_pk_bf16_f32 v187, v130, v131
    s_cmp_gt_u32 s26, 3
    s_cbranch_scc1 concat_heads__linear_attn_block__sliding_block__prompt_kernel_fendp4
    s_waitcnt lgkmcnt(2)
    v_mfma_f32_32x32x16_bf16 v[116:131], v[32:35], v[4:7], 0
    ds_read_b128 v[36:39], v24 offset:1024
    v_exp_f32 v100, v100
    v_exp_f32 v101, v101
    v_exp_f32 v102, v102
    v_exp_f32 v103, v103
    s_waitcnt lgkmcnt(1)
    v_mfma_f32_32x32x16_bf16 v[164:179], v[204:207], v[180:183], v[164:179]
    v_exp_f32 v104, v104
    v_exp_f32 v105, v105
    v_exp_f32 v106, v106
    v_exp_f32 v107, v107
    v_mfma_f32_32x32x16_bf16 v[164:179], v[208:211], v[184:187], v[164:179]
    ds_read_b128 v[196:199], v25 offset:3072
    ds_read_b128 v[200:203], v25 offset:3584
    v_exp_f32 v108, v108
    v_exp_f32 v109, v109
    v_exp_f32 v110, v110
    v_exp_f32 v111, v111
    v_exp_f32 v112, v112
    v_exp_f32 v113, v113
    v_exp_f32 v114, v114
    v_exp_f32 v115, v115
    s_nop 0
    v_cvt_pk_bf16_f32 v188, v100, v101
    v_cvt_pk_bf16_f32 v189, v102, v103
    v_cvt_pk_bf16_f32 v190, v104, v105
    v_cvt_pk_bf16_f32 v191, v106, v107
    v_cvt_pk_bf16_f32 v192, v108, v109
    v_cvt_pk_bf16_f32 v193, v110, v111
    v_cvt_pk_bf16_f32 v194, v112, v113
    v_cvt_pk_bf16_f32 v195, v114, v115
    s_cmp_gt_u32 s26, 2
    s_cbranch_scc1 concat_heads__linear_attn_block__sliding_block__prompt_kernel_fendp5
    s_waitcnt lgkmcnt(2)
    v_mfma_f32_32x32x16_bf16 v[100:115], v[36:39], v[4:7], 0
    v_exp_f32 v116, v116
    v_exp_f32 v117, v117
    v_exp_f32 v118, v118
    v_exp_f32 v119, v119
    s_waitcnt lgkmcnt(0)
    v_mfma_f32_32x32x16_bf16 v[164:179], v[196:199], v[188:191], v[164:179]
    v_exp_f32 v120, v120
    v_exp_f32 v121, v121
    v_exp_f32 v122, v122
    v_exp_f32 v123, v123
    v_mfma_f32_32x32x16_bf16 v[164:179], v[200:203], v[192:195], v[164:179]
    ds_read_b128 v[204:207], v25 offset:2048
    ds_read_b128 v[208:211], v25 offset:2560
    v_exp_f32 v124, v124
    v_exp_f32 v125, v125
    v_exp_f32 v126, v126
    v_exp_f32 v127, v127
    v_exp_f32 v128, v128
    v_exp_f32 v129, v129
    v_exp_f32 v130, v130
    v_exp_f32 v131, v131
    s_nop 0
    v_cvt_pk_bf16_f32 v180, v116, v117
    v_cvt_pk_bf16_f32 v181, v118, v119
    v_cvt_pk_bf16_f32 v182, v120, v121
    v_cvt_pk_bf16_f32 v183, v122, v123
    v_cvt_pk_bf16_f32 v184, v124, v125
    v_cvt_pk_bf16_f32 v185, v126, v127
    v_cvt_pk_bf16_f32 v186, v128, v129
    v_cvt_pk_bf16_f32 v187, v130, v131
    s_cmp_gt_u32 s26, 1
    s_cbranch_scc1 concat_heads__linear_attn_block__sliding_block__prompt_kernel_fendp6
    v_exp_f32 v100, v100
    v_exp_f32 v101, v101
    v_exp_f32 v102, v102
    v_exp_f32 v103, v103
    s_waitcnt lgkmcnt(0)
    v_mfma_f32_32x32x16_bf16 v[164:179], v[204:207], v[180:183], v[164:179]
    v_exp_f32 v104, v104
    v_exp_f32 v105, v105
    v_exp_f32 v106, v106
    v_exp_f32 v107, v107
    v_mfma_f32_32x32x16_bf16 v[164:179], v[208:211], v[184:187], v[164:179]
    ds_read_b128 v[196:199], v25 offset:1024
    ds_read_b128 v[200:203], v25 offset:1536
    v_exp_f32 v108, v108
    v_exp_f32 v109, v109
    v_exp_f32 v110, v110
    v_exp_f32 v111, v111
    v_exp_f32 v112, v112
    v_exp_f32 v113, v113
    v_exp_f32 v114, v114
    v_exp_f32 v115, v115
    s_nop 0
    v_cvt_pk_bf16_f32 v188, v100, v101
    v_cvt_pk_bf16_f32 v189, v102, v103
    v_cvt_pk_bf16_f32 v190, v104, v105
    v_cvt_pk_bf16_f32 v191, v106, v107
    v_cvt_pk_bf16_f32 v192, v108, v109
    v_cvt_pk_bf16_f32 v193, v110, v111
    v_cvt_pk_bf16_f32 v194, v112, v113
    v_cvt_pk_bf16_f32 v195, v114, v115
    s_waitcnt lgkmcnt(0)
    v_mfma_f32_32x32x16_bf16 v[164:179], v[196:199], v[188:191], v[164:179]
    v_mfma_f32_32x32x16_bf16 v[164:179], v[200:203], v[192:195], v[164:179]
    s_branch concat_heads__linear_attn_block__sliding_block__prompt_kernel_fend
concat_heads__linear_attn_block__sliding_block__prompt_kernel_fendp1:
    s_waitcnt lgkmcnt(0)
    s_nop 1
    v_mfma_f32_32x32x16_bf16 v[164:179], v[196:199], v[188:191], v[164:179]
    v_mfma_f32_32x32x16_bf16 v[164:179], v[200:203], v[192:195], v[164:179]
    s_branch concat_heads__linear_attn_block__sliding_block__prompt_kernel_fend
concat_heads__linear_attn_block__sliding_block__prompt_kernel_fendp2:
    s_waitcnt lgkmcnt(0)
    s_nop 1
    v_mfma_f32_32x32x16_bf16 v[164:179], v[204:207], v[180:183], v[164:179]
    v_mfma_f32_32x32x16_bf16 v[164:179], v[208:211], v[184:187], v[164:179]
    s_branch concat_heads__linear_attn_block__sliding_block__prompt_kernel_fend
concat_heads__linear_attn_block__sliding_block__prompt_kernel_fendp3:
    s_waitcnt lgkmcnt(0)
    s_nop 1
    v_mfma_f32_32x32x16_bf16 v[164:179], v[196:199], v[188:191], v[164:179]
    v_mfma_f32_32x32x16_bf16 v[164:179], v[200:203], v[192:195], v[164:179]
    s_branch concat_heads__linear_attn_block__sliding_block__prompt_kernel_fend
concat_heads__linear_attn_block__sliding_block__prompt_kernel_fendp4:
    s_waitcnt lgkmcnt(0)
    s_nop 1
    v_mfma_f32_32x32x16_bf16 v[164:179], v[204:207], v[180:183], v[164:179]
    v_mfma_f32_32x32x16_bf16 v[164:179], v[208:211], v[184:187], v[164:179]
    s_branch concat_heads__linear_attn_block__sliding_block__prompt_kernel_fend
concat_heads__linear_attn_block__sliding_block__prompt_kernel_fendp5:
    s_waitcnt lgkmcnt(0)
    s_nop 1
    v_mfma_f32_32x32x16_bf16 v[164:179], v[196:199], v[188:191], v[164:179]
    v_mfma_f32_32x32x16_bf16 v[164:179], v[200:203], v[192:195], v[164:179]
    s_branch concat_heads__linear_attn_block__sliding_block__prompt_kernel_fend
concat_heads__linear_attn_block__sliding_block__prompt_kernel_fendp6:
    s_waitcnt lgkmcnt(0)
    s_nop 1
    v_mfma_f32_32x32x16_bf16 v[164:179], v[204:207], v[180:183], v[164:179]
    v_mfma_f32_32x32x16_bf16 v[164:179], v[208:211], v[184:187], v[164:179]
concat_heads__linear_attn_block__sliding_block__prompt_kernel_fend:
    s_nop 15
    v_max3_f32 v28, |v164|, |v165|, |v166|
    v_max3_f32 v29, |v167|, |v168|, |v169|
    v_max3_f32 v28, v28, |v170|, |v171|
    v_max_f32 v28, v28, v29
    s_mov_b32 s28, 0x30800000
    s_mov_b32 s29, 0x5d800000
    v_cmp_nle_f32 vcc, s28, v172
    v_cmp_nge_f32 s[30:31], s29, v172
    s_or_b64 vcc, vcc, s[30:31]
    s_mov_b32 s28, 0x7b800000
    v_cmp_nge_f32 s[30:31], s28, v28
    s_or_b64 vcc, vcc, s[30:31]
    s_nop 4
    s_cbranch_vccnz concat_heads__linear_attn_block__sliding_block__prompt_kernel_slow
concat_heads__linear_attn_block__sliding_block__prompt_kernel_epi:
    v_rcp_f32 v172, v172
    s_nop 0
    v_mul_f32 v164, v164, v172
    v_mul_f32 v165, v165, v172
    v_mul_f32 v166, v166, v172
    v_mul_f32 v167, v167, v172
    v_mul_f32 v168, v168, v172
    v_mul_f32 v169, v169, v172
    v_mul_f32 v170, v170, v172
    v_mul_f32 v171, v171, v172
    v_cvt_pk_bf16_f32 v228, v164, v165
    v_cvt_pk_bf16_f32 v229, v166, v167
    v_cvt_pk_bf16_f32 v230, v168, v169
    v_cvt_pk_bf16_f32 v231, v170, v171
    s_lshl_b32 s24, s23, 5
    s_add_u32 s24, s24, s22
    s_lshl_b32 s24, s24, 10
    s_add_u32 s30, s24, 8388608
    s_add_u32 s24, s30, 2097152
    buffer_store_dwordx4 v[228:231], v3, s[8:11], s24 offen sc1
    s_waitcnt vmcnt(1)
    s_barrier
    v_lshlrev_b32 v27, 2, v0
    v_cmp_gt_u32 vcc, 272, v0
    s_and_saveexec_b64 s[28:29], vcc
    s_cbranch_execz concat_heads__linear_attn_block__sliding_block__prompt_kernel_nored
    ds_read_b32 v32, v27 offset:41984
    ds_read_b32 v33, v27 offset:43072
    ds_read_b32 v34, v27 offset:44160
    ds_read_b32 v35, v27 offset:45248
    ds_read_b32 v36, v27 offset:46336
    ds_read_b32 v37, v27 offset:47424
    ds_read_b32 v38, v27 offset:48512
    ds_read_b32 v39, v27 offset:49600
    ds_read_b32 v40, v27 offset:50688
    ds_read_b32 v41, v27 offset:51776
    ds_read_b32 v42, v27 offset:52864
    ds_read_b32 v43, v27 offset:53952
    s_waitcnt lgkmcnt(10)
    v_add_f32 v32, v32, v33
    s_waitcnt lgkmcnt(9)
    v_add_f32 v32, v32, v34
    s_waitcnt lgkmcnt(8)
    v_add_f32 v32, v32, v35
    ds_read_b32 v44, v27 offset:55040
    ds_read_b32 v45, v27 offset:56128
    ds_read_b32 v46, v27 offset:57216
    ds_read_b32 v47, v27 offset:58304
    s_waitcnt lgkmcnt(11)
    v_add_f32 v32, v32, v36
    s_waitcnt lgkmcnt(10)
    v_add_f32 v32, v32, v37
    s_waitcnt lgkmcnt(9)
    v_add_f32 v32, v32, v38
    s_waitcnt lgkmcnt(8)
    v_add_f32 v32, v32, v39
    s_waitcnt lgkmcnt(7)
    v_add_f32 v32, v32, v40
    s_waitcnt lgkmcnt(6)
    v_add_f32 v32, v32, v41
    s_waitcnt lgkmcnt(5)
    v_add_f32 v32, v32, v42
    s_waitcnt lgkmcnt(4)
    v_add_f32 v32, v32, v43
    s_waitcnt lgkmcnt(3)
    v_add_f32 v32, v32, v44
    s_waitcnt lgkmcnt(2)
    v_add_f32 v32, v32, v45
    s_waitcnt lgkmcnt(1)
    v_add_f32 v32, v32, v46
    s_waitcnt lgkmcnt(0)
    v_add_f32 v32, v32, v47
    ds_write_b32 v27, v32 offset:59392
concat_heads__linear_attn_block__sliding_block__prompt_kernel_nored:
    s_mov_b64 exec, s[28:29]
    s_waitcnt lgkmcnt(0)
    s_barrier
    ds_read_b128 v[236:239], v26
    ds_read_b128 v[240:243], v26 offset:16
    s_waitcnt lgkmcnt(0)
    v_cvt_pk_bf16_f32 v236, v236, v237
    v_cvt_pk_bf16_f32 v237, v238, v239
    v_cvt_pk_bf16_f32 v238, v240, v241
    v_cvt_pk_bf16_f32 v239, v242, v243
    s_nop 1
    v_mfma_f32_32x32x16_bf16 v[212:227], v[236:239], v[8:11], 0
    s_nop 15
    v_add_f32 v220, 0x358637bd, v220
    s_nop 0
    v_rcp_f32 v220, v220
    s_nop 0
    v_mul_f32 v212, v212, v220
    v_mul_f32 v213, v213, v220
    v_mul_f32 v214, v214, v220
    v_mul_f32 v215, v215, v220
    v_mul_f32 v216, v216, v220
    v_mul_f32 v217, v217, v220
    v_mul_f32 v218, v218, v220
    v_mul_f32 v219, v219, v220
    v_cvt_pk_bf16_f32 v232, v212, v213
    v_cvt_pk_bf16_f32 v233, v214, v215
    v_cvt_pk_bf16_f32 v234, v216, v217
    v_cvt_pk_bf16_f32 v235, v218, v219
    buffer_store_dwordx4 v[232:235], v3, s[8:11], s30 offen sc1
    s_waitcnt vmcnt(0)
    s_barrier
    s_cmp_lt_u32 s75, 4
    s_cbranch_scc1 concat_heads__linear_attn_block__sliding_block__prompt_kernel_wod
    v_lshrrev_b32 v4, 3, v1
    v_and_b32 v5, 7, v1
    v_bfe_u32 v6, v1, 4, 1
    v_lshlrev_b32 v6, 2, v6
    v_xor_b32 v6, v6, v5
    v_lshlrev_b32 v7, 10, v4
    v_lshl_add_u32 v7, v6, 4, v7
    s_cmp_eq_u32 s78, 0
    s_cselect_b32 s16, s64, s66
    s_cselect_b32 s17, s65, s67
    s_mov_b32 s18, 0x80000
    s_mov_b32 s19, 0x20000
    s_sub_u32 s29, s75, 4
    s_lshl_b32 s28, s77, 7
    s_lshl_b32 s24, s29, 13
    s_add_u32 s28, s28, s24
    s_lshl_b32 s29, s29, 10
    s_add_u32 m0, s29, 98304
    s_add_u32 s24, s28, 0
    buffer_load_dwordx4 v7, s[16:19], s24 offen lds
    s_add_u32 m0, s29, 102400
    s_add_u32 s24, s28, 32768
    buffer_load_dwordx4 v7, s[16:19], s24 offen lds
    s_add_u32 m0, s29, 106496
    s_add_u32 s24, s28, 65536
    buffer_load_dwordx4 v7, s[16:19], s24 offen lds
    s_add_u32 m0, s29, 110592
    s_add_u32 s24, s28, 98304
    buffer_load_dwordx4 v7, s[16:19], s24 offen lds
    s_add_u32 m0, s29, 114688
    s_add_u32 s24, s28, 131072
    buffer_load_dwordx4 v7, s[16:19], s24 offen lds
    s_add_u32 m0, s29, 118784
    s_add_u32 s24, s28, 163840
    buffer_load_dwordx4 v7, s[16:19], s24 offen lds
    s_add_u32 m0, s29, 122880
    s_add_u32 s24, s28, 196608
    buffer_load_dwordx4 v7, s[16:19], s24 offen lds
    s_add_u32 m0, s29, 126976
    s_add_u32 s24, s28, 229376
    buffer_load_dwordx4 v7, s[16:19], s24 offen lds
    s_add_u32 m0, s29, 131072
    s_add_u32 s24, s28, 262144
    buffer_load_dwordx4 v7, s[16:19], s24 offen lds
    s_add_u32 m0, s29, 135168
    s_add_u32 s24, s28, 294912
    buffer_load_dwordx4 v7, s[16:19], s24 offen lds
    s_add_u32 m0, s29, 139264
    s_add_u32 s24, s28, 327680
    buffer_load_dwordx4 v7, s[16:19], s24 offen lds
    s_add_u32 m0, s29, 143360
    s_add_u32 s24, s28, 360448
    buffer_load_dwordx4 v7, s[16:19], s24 offen lds
    s_add_u32 m0, s29, 147456
    s_add_u32 s24, s28, 393216
    buffer_load_dwordx4 v7, s[16:19], s24 offen lds
    s_add_u32 m0, s29, 151552
    s_add_u32 s24, s28, 425984
    buffer_load_dwordx4 v7, s[16:19], s24 offen lds
    s_add_u32 m0, s29, 155648
    s_add_u32 s24, s28, 458752
    buffer_load_dwordx4 v7, s[16:19], s24 offen lds
    s_add_u32 m0, s29, 159744
    s_add_u32 s24, s28, 491520
    buffer_load_dwordx4 v7, s[16:19], s24 offen lds
concat_heads__linear_attn_block__sliding_block__prompt_kernel_wod:
    s_cmp_lg_u32 s75, 0
    s_cbranch_scc1 concat_heads__linear_attn_block__sliding_block__prompt_kernel_nf2
    s_mul_i32 s24, s21, 4352
    s_lshl_b32 s25, s22, 7
    s_add_u32 s24, s24, s25
    s_add_u32 s24, s24, 13209600
    v_mov_b32 v12, 0
    v_mov_b32 v13, s74
    buffer_store_dword v13, v12, s[8:11], s24 offen sc1
    s_lshr_b32 s12, s76, 1
    s_mul_i32 s12, s12, 4352
    s_add_u32 s12, s12, 13209600
    s_mov_b32 s14, -1
    s_mov_b32 s15, 0
    s_mov_b32 s79, 0
    s_mov_b64 exec, s[14:15]
p3_7:
    buffer_load_dword v12, v2, s[8:11], s12 offen sc1
    s_waitcnt vmcnt(0)
    v_cmp_eq_u32 vcc, s74, v12
    s_cmp_eq_u64 vcc, s[14:15]
    s_cbranch_scc1 p3d_8
    s_add_u32 s79, s79, 1
    s_cmp_lt_u32 s79, 30000
    s_cbranch_scc0 p3d_8
    s_sleep 1
    s_branch p3_7
p3d_8:
    s_mov_b64 exec, -1
concat_heads__linear_attn_block__sliding_block__prompt_kernel_nf2:
    s_waitcnt vmcnt(0)
    s_barrier
    s_cmp_ge_u32 s75, 4
    s_cbranch_scc1 concat_heads__linear_attn_block__sliding_block__prompt_kernel_end
    s_lshl_b32 s27, s76, 2
    s_add_u32 s27, s27, s75
    s_lshl_b32 s24, s78, 6
    s_add_u32 s24, s24, s27
    s_lshl_b32 s28, s24, 15
    s_add_u32 s28, s28, 8388608
    s_add_u32 s25, s28, 0
    buffer_load_dwordx4 v[64:67], v3, s[8:11], s25 offen sc1
    s_add_u32 s25, s28, 1024
    buffer_load_dwordx4 v[68:71], v3, s[8:11], s25 offen sc1
    s_add_u32 s25, s28, 2048
    buffer_load_dwordx4 v[72:75], v3, s[8:11], s25 offen sc1
    s_add_u32 s25, s28, 3072
    buffer_load_dwordx4 v[76:79], v3, s[8:11], s25 offen sc1
    s_add_u32 s25, s28, 4096
    buffer_load_dwordx4 v[80:83], v3, s[8:11], s25 offen sc1
    s_add_u32 s25, s28, 5120
    buffer_load_dwordx4 v[84:87], v3, s[8:11], s25 offen sc1
    s_add_u32 s25, s28, 6144
    buffer_load_dwordx4 v[88:91], v3, s[8:11], s25 offen sc1
    s_add_u32 s25, s28, 7168
    buffer_load_dwordx4 v[92:95], v3, s[8:11], s25 offen sc1
    s_add_u32 s25, s28, 8192
    buffer_load_dwordx4 v[96:99], v3, s[8:11], s25 offen sc1
    s_add_u32 s25, s28, 9216
    buffer_load_dwordx4 v[100:103], v3, s[8:11], s25 offen sc1
    s_mov_b32 s16, s68
    s_mov_b32 s17, s69
    s_mov_b32 s18, 0x400000
    s_mov_b32 s19, 0x20000
    v_bfe_u32 v6, v1, 2, 2
    v_lshrrev_b32 v7, 5, v1
    v_lshl_add_u32 v6, v7, 2, v6
    v_lshlrev_b32 v6, 7, v6
    v_and_b32 v7, 1, v1
    v_lshlrev_b32 v7, 1, v7
    v_bfe_u32 v24, v1, 4, 1
    v_or_b32 v7, v7, v24
    v_bfe_u32 v24, v1, 3, 1
    v_lshlrev_b32 v24, 2, v24
    v_xor_b32 v7, v7, v24
    v_lshl_add_u32 v6, v7, 4, v6
    v_bfe_u32 v24, v1, 1, 1
    v_lshl_add_u32 v5, v24, 3, v6
    v_xor_b32 v6, 64, v5
    v_add_u32 v5, 98304, v5
    v_add_u32 v6, 98304, v6
    ds_read_b64_tr_b16 v[8:9], v5 offset:0
    ds_read_b64_tr_b16 v[10:11], v5 offset:1024
    ds_read_b64_tr_b16 v[12:13], v6 offset:0
    ds_read_b64_tr_b16 v[14:15], v6 offset:1024
    ds_read_b64_tr_b16 v[16:17], v5 offset:2048
    ds_read_b64_tr_b16 v[18:19], v5 offset:3072
    ds_read_b64_tr_b16 v[20:21], v6 offset:2048
    ds_read_b64_tr_b16 v[22:23], v6 offset:3072
    s_waitcnt vmcnt(9) lgkmcnt(4)
    v_mfma_f32_32x32x16_bf16 v[32:47], v[8:11], v[64:67], 0
    v_mfma_f32_32x32x16_bf16 v[48:63], v[12:15], v[64:67], 0
    s_add_u32 s25, s28, 10240
    buffer_load_dwordx4 v[104:107], v3, s[8:11], s25 offen sc1
    ds_read_b64_tr_b16 v[8:9], v5 offset:4096
    ds_read_b64_tr_b16 v[10:11], v5 offset:5120
    ds_read_b64_tr_b16 v[12:13], v6 offset:4096
    ds_read_b64_tr_b16 v[14:15], v6 offset:5120
    s_waitcnt vmcnt(9) lgkmcnt(4)
    v_mfma_f32_32x32x16_bf16 v[32:47], v[16:19], v[68:71], v[32:47]
    v_mfma_f32_32x32x16_bf16 v[48:63], v[20:23], v[68:71], v[48:63]
    s_add_u32 s25, s28, 11264
    buffer_load_dwordx4 v[108:111], v3, s[8:11], s25 offen sc1
    ds_read_b64_tr_b16 v[16:17], v5 offset:6144
    ds_read_b64_tr_b16 v[18:19], v5 offset:7168
    ds_read_b64_tr_b16 v[20:21], v6 offset:6144
    ds_read_b64_tr_b16 v[22:23], v6 offset:7168
    s_waitcnt vmcnt(9) lgkmcnt(4)
    v_mfma_f32_32x32x16_bf16 v[32:47], v[8:11], v[72:75], v[32:47]
    v_mfma_f32_32x32x16_bf16 v[48:63], v[12:15], v[72:75], v[48:63]
    s_add_u32 s25, s28, 12288
    buffer_load_dwordx4 v[112:115], v3, s[8:11], s25 offen sc1
    ds_read_b64_tr_b16 v[8:9], v5 offset:8192
    ds_read_b64_tr_b16 v[10:11], v5 offset:9216
    ds_read_b64_tr_b16 v[12:13], v6 offset:8192
    ds_read_b64_tr_b16 v[14:15], v6 offset:9216
    s_waitcnt vmcnt(9) lgkmcnt(4)
    v_mfma_f32_32x32x16_bf16 v[32:47], v[16:19], v[76:79], v[32:47]
    v_mfma_f32_32x32x16_bf16 v[48:63], v[20:23], v[76:79], v[48:63]
    s_add_u32 s25, s28, 13312
    buffer_load_dwordx4 v[116:119], v3, s[8:11], s25 offen sc1
    ds_read_b64_tr_b16 v[16:17], v5 offset:10240
    ds_read_b64_tr_b16 v[18:19], v5 offset:11264
    ds_read_b64_tr_b16 v[20:21], v6 offset:10240
    ds_read_b64_tr_b16 v[22:23], v6 offset:11264
    s_waitcnt vmcnt(9) lgkmcnt(4)
    v_mfma_f32_32x32x16_bf16 v[32:47], v[8:11], v[80:83], v[32:47]
    v_mfma_f32_32x32x16_bf16 v[48:63], v[12:15], v[80:83], v[48:63]
    s_add_u32 s25, s28, 14336
    buffer_load_dwordx4 v[120:123], v3, s[8:11], s25 offen sc1
    ds_read_b64_tr_b16 v[8:9], v5 offset:12288
    ds_read_b64_tr_b16 v[10:11], v5 offset:13312
    ds_read_b64_tr_b16 v[12:13], v6 offset:12288
    ds_read_b64_tr_b16 v[14:15], v6 offset:13312
    s_waitcnt vmcnt(9) lgkmcnt(4)
    v_mfma_f32_32x32x16_bf16 v[32:47], v[16:19], v[84:87], v[32:47]
    v_mfma_f32_32x32x16_bf16 v[48:63], v[20:23], v[84:87], v[48:63]
    s_add_u32 s25, s28, 15360
    buffer_load_dwordx4 v[124:127], v3, s[8:11], s25 offen sc1
    ds_read_b64_tr_b16 v[16:17], v5 offset:14336
    ds_read_b64_tr_b16 v[18:19], v5 offset:15360
    ds_read_b64_tr_b16 v[20:21], v6 offset:14336
    ds_read_b64_tr_b16 v[22:23], v6 offset:15360
    s_waitcnt vmcnt(9) lgkmcnt(4)
    v_mfma_f32_32x32x16_bf16 v[32:47], v[8:11], v[88:91], v[32:47]
    v_mfma_f32_32x32x16_bf16 v[48:63], v[12:15], v[88:91], v[48:63]
    s_add_u32 s25, s28, 16384
    buffer_load_dwordx4 v[128:131], v3, s[8:11], s25 offen sc1
    ds_read_b64_tr_b16 v[8:9], v5 offset:16384
    ds_read_b64_tr_b16 v[10:11], v5 offset:17408
    ds_read_b64_tr_b16 v[12:13], v6 offset:16384
    ds_read_b64_tr_b16 v[14:15], v6 offset:17408
    s_waitcnt vmcnt(9) lgkmcnt(4)
    v_mfma_f32_32x32x16_bf16 v[32:47], v[16:19], v[92:95], v[32:47]
    v_mfma_f32_32x32x16_bf16 v[48:63], v[20:23], v[92:95], v[48:63]
    s_add_u32 s25, s28, 17408
    buffer_load_dwordx4 v[132:135], v3, s[8:11], s25 offen sc1
    ds_read_b64_tr_b16 v[16:17], v5 offset:18432
    ds_read_b64_tr_b16 v[18:19], v5 offset:19456
    ds_read_b64_tr_b16 v[20:21], v6 offset:18432
    ds_read_b64_tr_b16 v[22:23], v6 offset:19456
    s_waitcnt vmcnt(9) lgkmcnt(4)
    v_mfma_f32_32x32x16_bf16 v[32:47], v[8:11], v[96:99], v[32:47]
    v_mfma_f32_32x32x16_bf16 v[48:63], v[12:15], v[96:99], v[48:63]
    s_add_u32 s25, s28, 18432
    buffer_load_dwordx4 v[136:139], v3, s[8:11], s25 offen sc1
    ds_read_b64_tr_b16 v[8:9], v5 offset:20480
    ds_read_b64_tr_b16 v[10:11], v5 offset:21504
    ds_read_b64_tr_b16 v[12:13], v6 offset:20480
    ds_read_b64_tr_b16 v[14:15], v6 offset:21504
    s_waitcnt vmcnt(9) lgkmcnt(4)
    v_mfma_f32_32x32x16_bf16 v[32:47], v[16:19], v[100:103], v[32:47]
    v_mfma_f32_32x32x16_bf16 v[48:63], v[20:23], v[100:103], v[48:63]
    s_add_u32 s25, s28, 19456
    buffer_load_dwordx4 v[140:143], v3, s[8:11], s25 offen sc1
    ds_read_b64_tr_b16 v[16:17], v5 offset:22528
    ds_read_b64_tr_b16 v[18:19], v5 offset:23552
    ds_read_b64_tr_b16 v[20:21], v6 offset:22528
    ds_read_b64_tr_b16 v[22:23], v6 offset:23552
    s_waitcnt vmcnt(9) lgkmcnt(4)
    v_mfma_f32_32x32x16_bf16 v[32:47], v[8:11], v[104:107], v[32:47]
    v_mfma_f32_32x32x16_bf16 v[48:63], v[12:15], v[104:107], v[48:63]
    s_add_u32 s25, s28, 20480
    buffer_load_dwordx4 v[144:147], v3, s[8:11], s25 offen sc1
    ds_read_b64_tr_b16 v[8:9], v5 offset:24576
    ds_read_b64_tr_b16 v[10:11], v5 offset:25600
    ds_read_b64_tr_b16 v[12:13], v6 offset:24576
    ds_read_b64_tr_b16 v[14:15], v6 offset:25600
    s_waitcnt vmcnt(9) lgkmcnt(4)
    v_mfma_f32_32x32x16_bf16 v[32:47], v[16:19], v[108:111], v[32:47]
    v_mfma_f32_32x32x16_bf16 v[48:63], v[20:23], v[108:111], v[48:63]
    s_add_u32 s25, s28, 21504
    buffer_load_dwordx4 v[148:151], v3, s[8:11], s25 offen sc1
    ds_read_b64_tr_b16 v[16:17], v5 offset:26624
    ds_read_b64_tr_b16 v[18:19], v5 offset:27648
    ds_read_b64_tr_b16 v[20:21], v6 offset:26624
    ds_read_b64_tr_b16 v[22:23], v6 offset:27648
    s_waitcnt vmcnt(9) lgkmcnt(4)
    v_mfma_f32_32x32x16_bf16 v[32:47], v[8:11], v[112:115], v[32:47]
    v_mfma_f32_32x32x16_bf16 v[48:63], v[12:15], v[112:115], v[48:63]
    s_add_u32 s25, s28, 22528
    buffer_load_dwordx4 v[152:155], v3, s[8:11], s25 offen sc1
    ds_read_b64_tr_b16 v[8:9], v5 offset:28672
    ds_read_b64_tr_b16 v[10:11], v5 offset:29696
    ds_read_b64_tr_b16 v[12:13], v6 offset:28672
    ds_read_b64_tr_b16 v[14:15], v6 offset:29696
    s_waitcnt vmcnt(9) lgkmcnt(4)
    v_mfma_f32_32x32x16_bf16 v[32:47], v[16:19], v[116:119], v[32:47]
    v_mfma_f32_32x32x16_bf16 v[48:63], v[20:23], v[116:119], v[48:63]
    s_add_u32 s25, s28, 23552
    buffer_load_dwordx4 v[156:159], v3, s[8:11], s25 offen sc1
    ds_read_b64_tr_b16 v[16:17], v5 offset:30720
    ds_read_b64_tr_b16 v[18:19], v5 offset:31744
    ds_read_b64_tr_b16 v[20:21], v6 offset:30720
    ds_read_b64_tr_b16 v[22:23], v6 offset:31744
    s_waitcnt vmcnt(9) lgkmcnt(4)
    v_mfma_f32_32x32x16_bf16 v[32:47], v[8:11], v[120:123], v[32:47]
    v_mfma_f32_32x32x16_bf16 v[48:63], v[12:15], v[120:123], v[48:63]
    s_add_u32 s25, s28, 24576
    buffer_load_dwordx4 v[160:163], v3, s[8:11], s25 offen sc1
    ds_read_b64_tr_b16 v[8:9], v5 offset:32768
    ds_read_b64_tr_b16 v[10:11], v5 offset:33792
    ds_read_b64_tr_b16 v[12:13], v6 offset:32768
    ds_read_b64_tr_b16 v[14:15], v6 offset:33792
    s_waitcnt vmcnt(9) lgkmcnt(4)
    v_mfma_f32_32x32x16_bf16 v[32:47], v[16:19], v[124:127], v[32:47]
    v_mfma_f32_32x32x16_bf16 v[48:63], v[20:23], v[124:127], v[48:63]
    s_add_u32 s25, s28, 25600
    buffer_load_dwordx4 v[164:167], v3, s[8:11], s25 offen sc1
    ds_read_b64_tr_b16 v[16:17], v5 offset:34816
    ds_read_b64_tr_b16 v[18:19], v5 offset:35840
    ds_read_b64_tr_b16 v[20:21], v6 offset:34816
    ds_read_b64_tr_b16 v[22:23], v6 offset:35840
    s_waitcnt vmcnt(9) lgkmcnt(4)
    v_mfma_f32_32x32x16_bf16 v[32:47], v[8:11], v[128:131], v[32:47]
    v_mfma_f32_32x32x16_bf16 v[48:63], v[12:15], v[128:131], v[48:63]
    s_add_u32 s25, s28, 26624
    buffer_load_dwordx4 v[168:171], v3, s[8:11], s25 offen sc1
    ds_read_b64_tr_b16 v[8:9], v5 offset:36864
    ds_read_b64_tr_b16 v[10:11], v5 offset:37888
    ds_read_b64_tr_b16 v[12:13], v6 offset:36864
    ds_read_b64_tr_b16 v[14:15], v6 offset:37888
    s_waitcnt vmcnt(9) lgkmcnt(4)
    v_mfma_f32_32x32x16_bf16 v[32:47], v[16:19], v[132:135], v[32:47]
    v_mfma_f32_32x32x16_bf16 v[48:63], v[20:23], v[132:135], v[48:63]
    s_add_u32 s25, s28, 27648
    buffer_load_dwordx4 v[172:175], v3, s[8:11], s25 offen sc1
    ds_read_b64_tr_b16 v[16:17], v5 offset:38912
    ds_read_b64_tr_b16 v[18:19], v5 offset:39936
    ds_read_b64_tr_b16 v[20:21], v6 offset:38912
    ds_read_b64_tr_b16 v[22:23], v6 offset:39936
    s_waitcnt vmcnt(9) lgkmcnt(4)
    v_mfma_f32_32x32x16_bf16 v[32:47], v[8:11], v[136:139], v[32:47]
    v_mfma_f32_32x32x16_bf16 v[48:63], v[12:15], v[136:139], v[48:63]
    s_add_u32 s25, s28, 28672
    buffer_load_dwordx4 v[176:179], v3, s[8:11], s25 offen sc1
    ds_read_b64_tr_b16 v[8:9], v5 offset:40960
    ds_read_b64_tr_b16 v[10:11], v5 offset:41984
    ds_read_b64_tr_b16 v[12:13], v6 offset:40960
    ds_read_b64_tr_b16 v[14:15], v6 offset:41984
    s_waitcnt vmcnt(9) lgkmcnt(4)
    v_mfma_f32_32x32x16_bf16 v[32:47], v[16:19], v[140:143], v[32:47]
    v_mfma_f32_32x32x16_bf16 v[48:63], v[20:23], v[140:143], v[48:63]
    s_add_u32 s25, s28, 29696
    buffer_load_dwordx4 v[180:183], v3, s[8:11], s25 offen sc1
    ds_read_b64_tr_b16 v[16:17], v5 offset:43008
    ds_read_b64_tr_b16 v[18:19], v5 offset:44032
    ds_read_b64_tr_b16 v[20:21], v6 offset:43008
    ds_read_b64_tr_b16 v[22:23], v6 offset:44032
    s_waitcnt vmcnt(9) lgkmcnt(4)
    v_mfma_f32_32x32x16_bf16 v[32:47], v[8:11], v[144:147], v[32:47]
    v_mfma_f32_32x32x16_bf16 v[48:63], v[12:15], v[144:147], v[48:63]
    s_add_u32 s25, s28, 30720
    buffer_load_dwordx4 v[184:187], v3, s[8:11], s25 offen sc1
    ds_read_b64_tr_b16 v[8:9], v5 offset:45056
    ds_read_b64_tr_b16 v[10:11], v5 offset:46080
    ds_read_b64_tr_b16 v[12:13], v6 offset:45056
    ds_read_b64_tr_b16 v[14:15], v6 offset:46080
    s_waitcnt vmcnt(9) lgkmcnt(4)
    v_mfma_f32_32x32x16_bf16 v[32:47], v[16:19], v[148:151], v[32:47]
    v_mfma_f32_32x32x16_bf16 v[48:63], v[20:23], v[148:151], v[48:63]
    s_add_u32 s25, s28, 31744
    buffer_load_dwordx4 v[188:191], v3, s[8:11], s25 offen sc1
    ds_read_b64_tr_b16 v[16:17], v5 offset:47104
    ds_read_b64_tr_b16 v[18:19], v5 offset:48128
    ds_read_b64_tr_b16 v[20:21], v6 offset:47104
    ds_read_b64_tr_b16 v[22:23], v6 offset:48128
    s_waitcnt vmcnt(9) lgkmcnt(4)
    v_mfma_f32_32x32x16_bf16 v[32:47], v[8:11], v[152:155], v[32:47]
    v_mfma_f32_32x32x16_bf16 v[48:63], v[12:15], v[152:155], v[48:63]
    ds_read_b64_tr_b16 v[8:9], v5 offset:49152
    ds_read_b64_tr_b16 v[10:11], v5 offset:50176
    ds_read_b64_tr_b16 v[12:13], v6 offset:49152
    ds_read_b64_tr_b16 v[14:15], v6 offset:50176
    s_waitcnt vmcnt(8) lgkmcnt(4)
    v_mfma_f32_32x32x16_bf16 v[32:47], v[16:19], v[156:159], v[32:47]
    v_mfma_f32_32x32x16_bf16 v[48:63], v[20:23], v[156:159], v[48:63]
    ds_read_b64_tr_b16 v[16:17], v5 offset:51200
    ds_read_b64_tr_b16 v[18:19], v5 offset:52224
    ds_read_b64_tr_b16 v[20:21], v6 offset:51200
    ds_read_b64_tr_b16 v[22:23], v6 offset:52224
    s_waitcnt vmcnt(7) lgkmcnt(4)
    v_mfma_f32_32x32x16_bf16 v[32:47], v[8:11], v[160:163], v[32:47]
    v_mfma_f32_32x32x16_bf16 v[48:63], v[12:15], v[160:163], v[48:63]
    ds_read_b64_tr_b16 v[8:9], v5 offset:53248
    ds_read_b64_tr_b16 v[10:11], v5 offset:54272
    ds_read_b64_tr_b16 v[12:13], v6 offset:53248
    ds_read_b64_tr_b16 v[14:15], v6 offset:54272
    s_waitcnt vmcnt(6) lgkmcnt(4)
    v_mfma_f32_32x32x16_bf16 v[32:47], v[16:19], v[164:167], v[32:47]
    v_mfma_f32_32x32x16_bf16 v[48:63], v[20:23], v[164:167], v[48:63]
    ds_read_b64_tr_b16 v[16:17], v5 offset:55296
    ds_read_b64_tr_b16 v[18:19], v5 offset:56320
    ds_read_b64_tr_b16 v[20:21], v6 offset:55296
    ds_read_b64_tr_b16 v[22:23], v6 offset:56320
    s_waitcnt vmcnt(5) lgkmcnt(4)
    v_mfma_f32_32x32x16_bf16 v[32:47], v[8:11], v[168:171], v[32:47]
    v_mfma_f32_32x32x16_bf16 v[48:63], v[12:15], v[168:171], v[48:63]
    ds_read_b64_tr_b16 v[8:9], v5 offset:57344
    ds_read_b64_tr_b16 v[10:11], v5 offset:58368
    ds_read_b64_tr_b16 v[12:13], v6 offset:57344
    ds_read_b64_tr_b16 v[14:15], v6 offset:58368
    s_waitcnt vmcnt(4) lgkmcnt(4)
    v_mfma_f32_32x32x16_bf16 v[32:47], v[16:19], v[172:175], v[32:47]
    v_mfma_f32_32x32x16_bf16 v[48:63], v[20:23], v[172:175], v[48:63]
    ds_read_b64_tr_b16 v[16:17], v5 offset:59392
    ds_read_b64_tr_b16 v[18:19], v5 offset:60416
    ds_read_b64_tr_b16 v[20:21], v6 offset:59392
    ds_read_b64_tr_b16 v[22:23], v6 offset:60416
    s_waitcnt vmcnt(3) lgkmcnt(4)
    v_mfma_f32_32x32x16_bf16 v[32:47], v[8:11], v[176:179], v[32:47]
    v_mfma_f32_32x32x16_bf16 v[48:63], v[12:15], v[176:179], v[48:63]
    ds_read_b64_tr_b16 v[8:9], v5 offset:61440
    ds_read_b64_tr_b16 v[10:11], v5 offset:62464
    ds_read_b64_tr_b16 v[12:13], v6 offset:61440
    ds_read_b64_tr_b16 v[14:15], v6 offset:62464
    s_waitcnt vmcnt(2) lgkmcnt(4)
    v_mfma_f32_32x32x16_bf16 v[32:47], v[16:19], v[180:183], v[32:47]
    v_mfma_f32_32x32x16_bf16 v[48:63], v[20:23], v[180:183], v[48:63]
    ds_read_b64_tr_b16 v[16:17], v5 offset:63488
    ds_read_b64_tr_b16 v[18:19], v5 offset:64512
    ds_read_b64_tr_b16 v[20:21], v6 offset:63488
    ds_read_b64_tr_b16 v[22:23], v6 offset:64512
    s_waitcnt vmcnt(1) lgkmcnt(4)
    v_mfma_f32_32x32x16_bf16 v[32:47], v[8:11], v[184:187], v[32:47]
    v_mfma_f32_32x32x16_bf16 v[48:63], v[12:15], v[184:187], v[48:63]
    s_waitcnt vmcnt(0) lgkmcnt(0)
    v_mfma_f32_32x32x16_bf16 v[32:47], v[16:19], v[188:191], v[32:47]
    v_mfma_f32_32x32x16_bf16 v[48:63], v[20:23], v[188:191], v[48:63]
    s_lshl_b32 s24, s27, 16
    s_lshl_b32 s25, s78, 10
    s_add_u32 s24, s24, s25
    s_lshl_b32 s25, s77, 7
    s_add_u32 s24, s24, s25
    v_and_b32 v6, 31, v1
    v_lshlrev_b32 v6, 11, v6
    v_lshrrev_b32 v7, 5, v1
    v_lshl_add_u32 v6, v7, 5, v6
    s_nop 7
    s_lshl_b32 s25, s75, 12
    v_and_b32 v8, 31, v1
    v_lshlrev_b32 v8, 7, v8
    v_lshrrev_b32 v9, 5, v1
    v_lshl_add_u32 v8, v9, 5, v8
    v_and_b32 v9, 7, v1
    v_lshlrev_b32 v9, 4, v9
    v_add_u32 v8, s25, v8
    v_cvt_pk_bf16_f32 v16, v32, v33
    v_cvt_pk_bf16_f32 v17, v34, v35
    v_cvt_pk_bf16_f32 v18, v36, v37
    v_cvt_pk_bf16_f32 v19, v38, v39
    v_cvt_pk_bf16_f32 v20, v40, v41
    v_cvt_pk_bf16_f32 v21, v42, v43
    v_cvt_pk_bf16_f32 v22, v44, v45
    v_cvt_pk_bf16_f32 v23, v46, v47
    v_cvt_pk_bf16_f32 v24, v48, v49
    v_cvt_pk_bf16_f32 v25, v50, v51
    v_cvt_pk_bf16_f32 v26, v52, v53
    v_cvt_pk_bf16_f32 v27, v54, v55
    v_cvt_pk_bf16_f32 v28, v56, v57
    v_cvt_pk_bf16_f32 v29, v58, v59
    v_cvt_pk_bf16_f32 v30, v60, v61
    v_cvt_pk_bf16_f32 v31, v62, v63
    v_add_u32 v10, 0, v8
    v_xor_b32 v10, v10, v9
    ds_write_b128 v10, v[16:19]
    v_add_u32 v10, 16, v8
    v_xor_b32 v10, v10, v9
    ds_write_b128 v10, v[20:23]
    v_add_u32 v10, 64, v8
    v_xor_b32 v10, v10, v9
    ds_write_b128 v10, v[24:27]
    v_add_u32 v10, 80, v8
    v_xor_b32 v10, v10, v9
    ds_write_b128 v10, v[28:31]
    v_lshrrev_b32 v11, 3, v1
    v_and_b32 v12, 7, v1
    v_xor_b32 v13, v12, v11
    v_lshlrev_b32 v13, 4, v13
    v_lshl_add_u32 v13, v11, 7, v13
    v_add_u32 v13, s25, v13
    v_lshlrev_b32 v14, 11, v11
    v_lshl_add_u32 v14, v12, 4, v14
    s_waitcnt lgkmcnt(0)
    ds_read_b128 v[32:35], v13 offset:0
    ds_read_b128 v[36:39], v13 offset:1024
    ds_read_b128 v[40:43], v13 offset:2048
    ds_read_b128 v[44:47], v13 offset:3072
    s_waitcnt lgkmcnt(3)
    s_add_u32 s25, s24, 0
    buffer_store_dwordx4 v[32:35], v14, s[16:19], s25 offen nt
    s_waitcnt lgkmcnt(2)
    s_add_u32 s25, s24, 16384
    buffer_store_dwordx4 v[36:39], v14, s[16:19], s25 offen nt
    s_waitcnt lgkmcnt(1)
    s_add_u32 s25, s24, 32768
    buffer_store_dwordx4 v[40:43], v14, s[16:19], s25 offen nt
    s_waitcnt lgkmcnt(0)
    s_add_u32 s25, s24, 49152
    buffer_store_dwordx4 v[44:47], v14, s[16:19], s25 offen nt
    s_cmp_lg_u32 s2, 0
    s_cbranch_scc1 concat_heads__linear_attn_block__sliding_block__prompt_kernel_nn
    s_cmp_lg_u32 s75, 0
    s_cbranch_scc1 concat_heads__linear_attn_block__sliding_block__prompt_kernel_nn
    s_mov_b32 s24, 13244416
    v_mov_b32 v12, 0
    v_mov_b32 v13, s74
    buffer_store_dword v13, v12, s[8:11], s24 offen sc1
concat_heads__linear_attn_block__sliding_block__prompt_kernel_nn:
concat_heads__linear_attn_block__sliding_block__prompt_kernel_end:
    s_endpgm
concat_heads__linear_attn_block__sliding_block__prompt_kernel_slow:
    s_waitcnt lgkmcnt(0)
    ds_read_b128 v[32:35], v24 offset:0
    ds_read_b128 v[64:67], v24 offset:8192
    ds_read_b128 v[60:63], v24 offset:7168
    ds_read_b128 v[56:59], v24 offset:6144
    ds_read_b128 v[52:55], v24 offset:5120
    ds_read_b128 v[48:51], v24 offset:4096
    ds_read_b128 v[44:47], v24 offset:3072
    ds_read_b128 v[40:43], v24 offset:2048
    ds_read_b128 v[36:39], v24 offset:1024
    s_waitcnt lgkmcnt(0)
    s_cmp_eq_u32 s21, 0
    s_cbranch_scc1 concat_heads__linear_attn_block__sliding_block__prompt_kernel_rb0a
    v_mfma_f32_32x32x16_bf16 v[68:83], v[32:35], v[4:7], 0
    s_branch concat_heads__linear_attn_block__sliding_block__prompt_kernel_rb0b
concat_heads__linear_attn_block__sliding_block__prompt_kernel_rb0a:
    v_mov_b32 v68, 0xf149f2ca
    v_mov_b32 v69, 0xf149f2ca
    v_mov_b32 v70, 0xf149f2ca
    v_mov_b32 v71, 0xf149f2ca
    v_mov_b32 v72, 0xf149f2ca
    v_mov_b32 v73, 0xf149f2ca
    v_mov_b32 v74, 0xf149f2ca
    v_mov_b32 v75, 0xf149f2ca
    v_mov_b32 v76, 0xf149f2ca
    v_mov_b32 v77, 0xf149f2ca
    v_mov_b32 v78, 0xf149f2ca
    v_mov_b32 v79, 0xf149f2ca
    v_mov_b32 v80, 0xf149f2ca
    v_mov_b32 v81, 0xf149f2ca
    v_mov_b32 v82, 0xf149f2ca
    v_mov_b32 v83, 0xf149f2ca
concat_heads__linear_attn_block__sliding_block__prompt_kernel_rb0b:
    v_mfma_f32_32x32x16_bf16 v[84:99], v[64:67], v[4:7], 0
    v_mfma_f32_32x32x16_bf16 v[100:115], v[60:63], v[4:7], 0
    v_mfma_f32_32x32x16_bf16 v[116:131], v[56:59], v[4:7], 0
    s_nop 15
    v_cndmask_b32_e64 v132, v68, v84, s[32:33]
    v_cndmask_b32_e64 v133, v69, v85, s[34:35]
    v_cndmask_b32_e64 v134, v70, v86, s[36:37]
    v_cndmask_b32_e64 v135, v71, v87, s[38:39]
    v_cndmask_b32_e64 v136, v72, v88, s[40:41]
    v_cndmask_b32_e64 v137, v73, v89, s[42:43]
    v_cndmask_b32_e64 v138, v74, v90, s[44:45]
    v_cndmask_b32_e64 v139, v75, v91, s[46:47]
    v_cndmask_b32_e64 v140, v76, v92, s[48:49]
    v_cndmask_b32_e64 v141, v77, v93, s[50:51]
    v_cndmask_b32_e64 v142, v78, v94, s[52:53]
    v_cndmask_b32_e64 v143, v79, v95, s[54:55]
    v_cndmask_b32_e64 v144, v80, v96, s[56:57]
    v_cndmask_b32_e64 v145, v81, v97, s[58:59]
    v_cndmask_b32_e64 v146, v82, v98, s[60:61]
    v_cndmask_b32_e64 v147, v83, v99, s[62:63]
    v_max3_f32 v28, v132, v133, v134
    v_max3_f32 v28, v28, v135, v136
    v_max3_f32 v28, v28, v137, v138
    v_max3_f32 v28, v28, v139, v140
    v_max3_f32 v28, v28, v141, v142
    v_max3_f32 v28, v28, v143, v144
    v_max3_f32 v28, v28, v145, v146
    v_max_f32 v28, v28, v147
    s_cmp_gt_u32 s26, 7
    s_cbranch_scc1 concat_heads__linear_attn_block__sliding_block__prompt_kernel_p1end
    v_mfma_f32_32x32x16_bf16 v[68:83], v[52:55], v[4:7], 0
    v_mfma_f32_32x32x16_bf16 v[84:99], v[48:51], v[4:7], 0
    v_max3_f32 v28, v28, v100, v101
    v_max3_f32 v28, v28, v102, v103
    v_max3_f32 v28, v28, v104, v105
    v_max3_f32 v28, v28, v106, v107
    v_max3_f32 v28, v28, v108, v109
    v_max3_f32 v28, v28, v110, v111
    v_max3_f32 v28, v28, v112, v113
    v_max3_f32 v28, v28, v114, v115
    s_cmp_gt_u32 s26, 6
    s_cbranch_scc1 concat_heads__linear_attn_block__sliding_block__prompt_kernel_p1end
    v_max3_f32 v28, v28, v116, v117
    v_max3_f32 v28, v28, v118, v119
    v_max3_f32 v28, v28, v120, v121
    v_max3_f32 v28, v28, v122, v123
    v_max3_f32 v28, v28, v124, v125
    v_max3_f32 v28, v28, v126, v127
    v_max3_f32 v28, v28, v128, v129
    v_max3_f32 v28, v28, v130, v131
    s_cmp_gt_u32 s26, 5
    s_cbranch_scc1 concat_heads__linear_attn_block__sliding_block__prompt_kernel_p1end
    v_mfma_f32_32x32x16_bf16 v[100:115], v[44:47], v[4:7], 0
    v_mfma_f32_32x32x16_bf16 v[116:131], v[40:43], v[4:7], 0
    v_max3_f32 v28, v28, v68, v69
    v_max3_f32 v28, v28, v70, v71
    v_max3_f32 v28, v28, v72, v73
    v_max3_f32 v28, v28, v74, v75
    v_max3_f32 v28, v28, v76, v77
    v_max3_f32 v28, v28, v78, v79
    v_max3_f32 v28, v28, v80, v81
    v_max3_f32 v28, v28, v82, v83
    s_cmp_gt_u32 s26, 4
    s_cbranch_scc1 concat_heads__linear_attn_block__sliding_block__prompt_kernel_p1end
    v_max3_f32 v28, v28, v84, v85
    v_max3_f32 v28, v28, v86, v87
    v_max3_f32 v28, v28, v88, v89
    v_max3_f32 v28, v28, v90, v91
    v_max3_f32 v28, v28, v92, v93
    v_max3_f32 v28, v28, v94, v95
    v_max3_f32 v28, v28, v96, v97
    v_max3_f32 v28, v28, v98, v99
    s_cmp_gt_u32 s26, 3
    s_cbranch_scc1 concat_heads__linear_attn_block__sliding_block__prompt_kernel_p1end
    v_mfma_f32_32x32x16_bf16 v[68:83], v[36:39], v[4:7], 0
    v_max3_f32 v28, v28, v100, v101
    v_max3_f32 v28, v28, v102, v103
    v_max3_f32 v28, v28, v104, v105
    v_max3_f32 v28, v28, v106, v107
    v_max3_f32 v28, v28, v108, v109
    v_max3_f32 v28, v28, v110, v111
    v_max3_f32 v28, v28, v112, v113
    v_max3_f32 v28, v28, v114, v115
    s_cmp_gt_u32 s26, 2
    s_cbranch_scc1 concat_heads__linear_attn_block__sliding_block__prompt_kernel_p1end
    v_max3_f32 v28, v28, v116, v117
    v_max3_f32 v28, v28, v118, v119
    v_max3_f32 v28, v28, v120, v121
    v_max3_f32 v28, v28, v122, v123
    v_max3_f32 v28, v28, v124, v125
    v_max3_f32 v28, v28, v126, v127
    v_max3_f32 v28, v28, v128, v129
    v_max3_f32 v28, v28, v130, v131
    s_cmp_gt_u32 s26, 1
    s_cbranch_scc1 concat_heads__linear_attn_block__sliding_block__prompt_kernel_p1end
    s_nop 1
    v_max3_f32 v28, v28, v68, v69
    v_max3_f32 v28, v28, v70, v71
    v_max3_f32 v28, v28, v72, v73
    v_max3_f32 v28, v28, v74, v75
    v_max3_f32 v28, v28, v76, v77
    v_max3_f32 v28, v28, v78, v79
    v_max3_f32 v28, v28, v80, v81
    v_max3_f32 v28, v28, v82, v83
concat_heads__linear_attn_block__sliding_block__prompt_kernel_p1end:
    v_mov_b32 v29, v28
    s_nop 1
    v_permlane32_swap_b32 v29, v28
    s_nop 1
    v_max_f32 v28, v28, v29
    v_sub_f32 v148, 0, v28
    v_mov_b32 v149, v148
    v_mov_b32 v150, v148
    v_mov_b32 v151, v148
    v_mov_b32 v152, v148
    v_mov_b32 v153, v148
    v_mov_b32 v154, v148
    v_mov_b32 v155, v148
    v_mov_b32 v156, v148
    v_mov_b32 v157, v148
    v_mov_b32 v158, v148
    v_mov_b32 v159, v148
    v_mov_b32 v160, v148
    v_mov_b32 v161, v148
    v_mov_b32 v162, v148
    v_mov_b32 v163, v148
    ds_read_b128 v[196:199], v25 offset:8192
    ds_read_b128 v[200:203], v25 offset:8704
    ds_read_b128 v[204:207], v25 offset:0
    ds_read_b128 v[208:211], v25 offset:512
    v_mfma_f32_32x32x16_bf16 v[100:115], v[60:63], v[4:7], v[148:163]
    v_pk_add_f32 v[132:133], v[132:133], v[148:149]
    v_pk_add_f32 v[134:135], v[134:135], v[148:149]
    v_pk_add_f32 v[136:137], v[136:137], v[148:149]
    v_pk_add_f32 v[138:139], v[138:139], v[148:149]
    v_pk_add_f32 v[140:141], v[140:141], v[148:149]
    v_pk_add_f32 v[142:143], v[142:143], v[148:149]
    v_pk_add_f32 v[144:145], v[144:145], v[148:149]
    v_pk_add_f32 v[146:147], v[146:147], v[148:149]
    v_exp_f32 v132, v132
    v_exp_f32 v133, v133
    v_exp_f32 v134, v134
    v_exp_f32 v135, v135
    v_exp_f32 v136, v136
    v_exp_f32 v137, v137
    v_exp_f32 v138, v138
    v_exp_f32 v139, v139
    v_exp_f32 v140, v140
    v_exp_f32 v141, v141
    v_exp_f32 v142, v142
    v_exp_f32 v143, v143
    v_exp_f32 v144, v144
    v_exp_f32 v145, v145
    v_exp_f32 v146, v146
    v_exp_f32 v147, v147
    s_nop 0
    v_cvt_pk_bf16_f32 v180, v132, v133
    v_cvt_pk_bf16_f32 v181, v134, v135
    v_cvt_pk_bf16_f32 v182, v136, v137
    v_cvt_pk_bf16_f32 v183, v138, v139
    v_cvt_pk_bf16_f32 v184, v140, v141
    v_cvt_pk_bf16_f32 v185, v142, v143
    v_cvt_pk_bf16_f32 v186, v144, v145
    v_cvt_pk_bf16_f32 v187, v146, v147
    v_and_b32 v188, v180, v16
    v_and_b32 v189, v181, v17
    v_and_b32 v190, v182, v18
    v_and_b32 v191, v183, v19
    v_and_b32 v192, v184, v20
    v_and_b32 v193, v185, v21
    v_and_b32 v194, v186, v22
    v_and_b32 v195, v187, v23
    v_xor_b32 v180, v180, v188
    v_xor_b32 v181, v181, v189
    v_xor_b32 v182, v182, v190
    v_xor_b32 v183, v183, v191
    v_xor_b32 v184, v184, v192
    v_xor_b32 v185, v185, v193
    v_xor_b32 v186, v186, v194
    v_xor_b32 v187, v187, v195
    s_waitcnt lgkmcnt(0)
    v_mfma_f32_32x32x16_bf16 v[164:179], v[196:199], v[188:191], 0
    v_mfma_f32_32x32x16_bf16 v[164:179], v[200:203], v[192:195], v[164:179]
    s_cmp_eq_u32 s21, 0
    s_cbranch_scc1 concat_heads__linear_attn_block__sliding_block__prompt_kernel_skip0
    v_mfma_f32_32x32x16_bf16 v[164:179], v[204:207], v[180:183], v[164:179]
    v_mfma_f32_32x32x16_bf16 v[164:179], v[208:211], v[184:187], v[164:179]
concat_heads__linear_attn_block__sliding_block__prompt_kernel_skip0:
    s_cmp_gt_u32 s26, 7
    s_cbranch_scc1 concat_heads__linear_attn_block__sliding_block__prompt_kernel_p2end
    ds_read_b128 v[196:199], v25 offset:7168
    ds_read_b128 v[200:203], v25 offset:7680
    v_mfma_f32_32x32x16_bf16 v[116:131], v[56:59], v[4:7], v[148:163]
    v_exp_f32 v100, v100
    v_exp_f32 v101, v101
    v_exp_f32 v102, v102
    v_exp_f32 v103, v103
    v_exp_f32 v104, v104
    v_exp_f32 v105, v105
    v_exp_f32 v106, v106
    v_exp_f32 v107, v107
    v_exp_f32 v108, v108
    v_exp_f32 v109, v109
    v_exp_f32 v110, v110
    v_exp_f32 v111, v111
    v_exp_f32 v112, v112
    v_exp_f32 v113, v113
    v_exp_f32 v114, v114
    v_exp_f32 v115, v115
    s_nop 0
    v_cvt_pk_bf16_f32 v180, v100, v101
    v_cvt_pk_bf16_f32 v181, v102, v103
    v_cvt_pk_bf16_f32 v182, v104, v105
    v_cvt_pk_bf16_f32 v183, v106, v107
    v_cvt_pk_bf16_f32 v184, v108, v109
    v_cvt_pk_bf16_f32 v185, v110, v111
    v_cvt_pk_bf16_f32 v186, v112, v113
    v_cvt_pk_bf16_f32 v187, v114, v115
    s_waitcnt lgkmcnt(0)
    v_mfma_f32_32x32x16_bf16 v[164:179], v[196:199], v[180:183], v[164:179]
    v_mfma_f32_32x32x16_bf16 v[164:179], v[200:203], v[184:187], v[164:179]
    s_cmp_gt_u32 s26, 6
    s_cbranch_scc1 concat_heads__linear_attn_block__sliding_block__prompt_kernel_p2end
    ds_read_b128 v[204:207], v25 offset:6144
    ds_read_b128 v[208:211], v25 offset:6656
    v_mfma_f32_32x32x16_bf16 v[100:115], v[52:55], v[4:7], v[148:163]
    v_exp_f32 v116, v116
    v_exp_f32 v117, v117
    v_exp_f32 v118, v118
    v_exp_f32 v119, v119
    v_exp_f32 v120, v120
    v_exp_f32 v121, v121
    v_exp_f32 v122, v122
    v_exp_f32 v123, v123
    v_exp_f32 v124, v124
    v_exp_f32 v125, v125
    v_exp_f32 v126, v126
    v_exp_f32 v127, v127
    v_exp_f32 v128, v128
    v_exp_f32 v129, v129
    v_exp_f32 v130, v130
    v_exp_f32 v131, v131
    s_nop 0
    v_cvt_pk_bf16_f32 v188, v116, v117
    v_cvt_pk_bf16_f32 v189, v118, v119
    v_cvt_pk_bf16_f32 v190, v120, v121
    v_cvt_pk_bf16_f32 v191, v122, v123
    v_cvt_pk_bf16_f32 v192, v124, v125
    v_cvt_pk_bf16_f32 v193, v126, v127
    v_cvt_pk_bf16_f32 v194, v128, v129
    v_cvt_pk_bf16_f32 v195, v130, v131
    s_waitcnt lgkmcnt(0)
    v_mfma_f32_32x32x16_bf16 v[164:179], v[204:207], v[188:191], v[164:179]
    v_mfma_f32_32x32x16_bf16 v[164:179], v[208:211], v[192:195], v[164:179]
    s_cmp_gt_u32 s26, 5
    s_cbranch_scc1 concat_heads__linear_attn_block__sliding_block__prompt_kernel_p2end
    ds_read_b128 v[196:199], v25 offset:5120
    ds_read_b128 v[200:203], v25 offset:5632
    v_mfma_f32_32x32x16_bf16 v[116:131], v[48:51], v[4:7], v[148:163]
    v_exp_f32 v100, v100
    v_exp_f32 v101, v101
    v_exp_f32 v102, v102
    v_exp_f32 v103, v103
    v_exp_f32 v104, v104
    v_exp_f32 v105, v105
    v_exp_f32 v106, v106
    v_exp_f32 v107, v107
    v_exp_f32 v108, v108
    v_exp_f32 v109, v109
    v_exp_f32 v110, v110
    v_exp_f32 v111, v111
    v_exp_f32 v112, v112
    v_exp_f32 v113, v113
    v_exp_f32 v114, v114
    v_exp_f32 v115, v115
    s_nop 0
    v_cvt_pk_bf16_f32 v180, v100, v101
    v_cvt_pk_bf16_f32 v181, v102, v103
    v_cvt_pk_bf16_f32 v182, v104, v105
    v_cvt_pk_bf16_f32 v183, v106, v107
    v_cvt_pk_bf16_f32 v184, v108, v109
    v_cvt_pk_bf16_f32 v185, v110, v111
    v_cvt_pk_bf16_f32 v186, v112, v113
    v_cvt_pk_bf16_f32 v187, v114, v115
    s_waitcnt lgkmcnt(0)
    v_mfma_f32_32x32x16_bf16 v[164:179], v[196:199], v[180:183], v[164:179]
    v_mfma_f32_32x32x16_bf16 v[164:179], v[200:203], v[184:187], v[164:179]
    s_cmp_gt_u32 s26, 4
    s_cbranch_scc1 concat_heads__linear_attn_block__sliding_block__prompt_kernel_p2end
    ds_read_b128 v[204:207], v25 offset:4096
    ds_read_b128 v[208:211], v25 offset:4608
    v_mfma_f32_32x32x16_bf16 v[100:115], v[44:47], v[4:7], v[148:163]
    v_exp_f32 v116, v116
    v_exp_f32 v117, v117
    v_exp_f32 v118, v118
    v_exp_f32 v119, v119
    v_exp_f32 v120, v120
    v_exp_f32 v121, v121
    v_exp_f32 v122, v122
    v_exp_f32 v123, v123
    v_exp_f32 v124, v124
    v_exp_f32 v125, v125
    v_exp_f32 v126, v126
    v_exp_f32 v127, v127
    v_exp_f32 v128, v128
    v_exp_f32 v129, v129
    v_exp_f32 v130, v130
    v_exp_f32 v131, v131
    s_nop 0
    v_cvt_pk_bf16_f32 v188, v116, v117
    v_cvt_pk_bf16_f32 v189, v118, v119
    v_cvt_pk_bf16_f32 v190, v120, v121
    v_cvt_pk_bf16_f32 v191, v122, v123
    v_cvt_pk_bf16_f32 v192, v124, v125
    v_cvt_pk_bf16_f32 v193, v126, v127
    v_cvt_pk_bf16_f32 v194, v128, v129
    v_cvt_pk_bf16_f32 v195, v130, v131
    s_waitcnt lgkmcnt(0)
    v_mfma_f32_32x32x16_bf16 v[164:179], v[204:207], v[188:191], v[164:179]
    v_mfma_f32_32x32x16_bf16 v[164:179], v[208:211], v[192:195], v[164:179]
    s_cmp_gt_u32 s26, 3
    s_cbranch_scc1 concat_heads__linear_attn_block__sliding_block__prompt_kernel_p2end
    ds_read_b128 v[196:199], v25 offset:3072
    ds_read_b128 v[200:203], v25 offset:3584
    v_mfma_f32_32x32x16_bf16 v[116:131], v[40:43], v[4:7], v[148:163]
    v_exp_f32 v100, v100
    v_exp_f32 v101, v101
    v_exp_f32 v102, v102
    v_exp_f32 v103, v103
    v_exp_f32 v104, v104
    v_exp_f32 v105, v105
    v_exp_f32 v106, v106
    v_exp_f32 v107, v107
    v_exp_f32 v108, v108
    v_exp_f32 v109, v109
    v_exp_f32 v110, v110
    v_exp_f32 v111, v111
    v_exp_f32 v112, v112
    v_exp_f32 v113, v113
    v_exp_f32 v114, v114
    v_exp_f32 v115, v115
    s_nop 0
    v_cvt_pk_bf16_f32 v180, v100, v101
    v_cvt_pk_bf16_f32 v181, v102, v103
    v_cvt_pk_bf16_f32 v182, v104, v105
    v_cvt_pk_bf16_f32 v183, v106, v107
    v_cvt_pk_bf16_f32 v184, v108, v109
    v_cvt_pk_bf16_f32 v185, v110, v111
    v_cvt_pk_bf16_f32 v186, v112, v113
    v_cvt_pk_bf16_f32 v187, v114, v115
    s_waitcnt lgkmcnt(0)
    v_mfma_f32_32x32x16_bf16 v[164:179], v[196:199], v[180:183], v[164:179]
    v_mfma_f32_32x32x16_bf16 v[164:179], v[200:203], v[184:187], v[164:179]
    s_cmp_gt_u32 s26, 2
    s_cbranch_scc1 concat_heads__linear_attn_block__sliding_block__prompt_kernel_p2end
    ds_read_b128 v[204:207], v25 offset:2048
    ds_read_b128 v[208:211], v25 offset:2560
    v_mfma_f32_32x32x16_bf16 v[100:115], v[36:39], v[4:7], v[148:163]
    v_exp_f32 v116, v116
    v_exp_f32 v117, v117
    v_exp_f32 v118, v118
    v_exp_f32 v119, v119
    v_exp_f32 v120, v120
    v_exp_f32 v121, v121
    v_exp_f32 v122, v122
    v_exp_f32 v123, v123
    v_exp_f32 v124, v124
    v_exp_f32 v125, v125
    v_exp_f32 v126, v126
    v_exp_f32 v127, v127
    v_exp_f32 v128, v128
    v_exp_f32 v129, v129
    v_exp_f32 v130, v130
    v_exp_f32 v131, v131
    s_nop 0
    v_cvt_pk_bf16_f32 v188, v116, v117
    v_cvt_pk_bf16_f32 v189, v118, v119
    v_cvt_pk_bf16_f32 v190, v120, v121
    v_cvt_pk_bf16_f32 v191, v122, v123
    v_cvt_pk_bf16_f32 v192, v124, v125
    v_cvt_pk_bf16_f32 v193, v126, v127
    v_cvt_pk_bf16_f32 v194, v128, v129
    v_cvt_pk_bf16_f32 v195, v130, v131
    s_waitcnt lgkmcnt(0)
    v_mfma_f32_32x32x16_bf16 v[164:179], v[204:207], v[188:191], v[164:179]
    v_mfma_f32_32x32x16_bf16 v[164:179], v[208:211], v[192:195], v[164:179]
    s_cmp_gt_u32 s26, 1
    s_cbranch_scc1 concat_heads__linear_attn_block__sliding_block__prompt_kernel_p2end
    ds_read_b128 v[196:199], v25 offset:1024
    ds_read_b128 v[200:203], v25 offset:1536
    v_exp_f32 v100, v100
    v_exp_f32 v101, v101
    v_exp_f32 v102, v102
    v_exp_f32 v103, v103
    v_exp_f32 v104, v104
    v_exp_f32 v105, v105
    v_exp_f32 v106, v106
    v_exp_f32 v107, v107
    v_exp_f32 v108, v108
    v_exp_f32 v109, v109
    v_exp_f32 v110, v110
    v_exp_f32 v111, v111
    v_exp_f32 v112, v112
    v_exp_f32 v113, v113
    v_exp_f32 v114, v114
    v_exp_f32 v115, v115
    s_nop 0
    v_cvt_pk_bf16_f32 v180, v100, v101
    v_cvt_pk_bf16_f32 v181, v102, v103
    v_cvt_pk_bf16_f32 v182, v104, v105
    v_cvt_pk_bf16_f32 v183, v106, v107
    v_cvt_pk_bf16_f32 v184, v108, v109
    v_cvt_pk_bf16_f32 v185, v110, v111
    v_cvt_pk_bf16_f32 v186, v112, v113
    v_cvt_pk_bf16_f32 v187, v114, v115
    s_waitcnt lgkmcnt(0)
    v_mfma_f32_32x32x16_bf16 v[164:179], v[196:199], v[180:183], v[164:179]
    v_mfma_f32_32x32x16_bf16 v[164:179], v[200:203], v[184:187], v[164:179]
concat_heads__linear_attn_block__sliding_block__prompt_kernel_p2end:
    s_nop 15
    s_branch concat_heads__linear_attn_block__sliding_block__prompt_kernel_epi
concat_heads__linear_attn_block__sliding_block__prompt_kernel_last:
    s_endpgm

.section .rodata,"a"
.p2align 6
.amdhsa_kernel concat_heads__linear_attn_block__sliding_block__prompt_kernel
  .amdhsa_next_free_vgpr 248
  .amdhsa_next_free_sgpr 102
  .amdhsa_accum_offset 248
  .amdhsa_group_segment_fixed_size 0
  .amdhsa_kernarg_size 72
  .amdhsa_user_sgpr_count 2
  .amdhsa_user_sgpr_kernarg_segment_ptr 1
  .amdhsa_system_sgpr_workgroup_id_x 1
  .amdhsa_float_denorm_mode_32 3
.end_amdhsa_kernel
```
